```python
import torch

def _softmax(x, axis=-1):
    return torch.softmax(x, dim=axis)
def _gelu(x):
    return torch.nn.functional.gelu(x, approximate="tanh")
def _silu(x):
    return torch.nn.functional.silu(x)
def _sigmoid(x):
    return torch.sigmoid(x)
def _layernorm(x, axis=-1, eps=1e-5):
    m = x.mean(dim=axis, keepdim=True)
    v = x.var(dim=axis, keepdim=True, unbiased=False)
    return (x - m) / torch.sqrt(v + eps)
def _scatter_add(tgt, idx, src, axis=0):
    return tgt.clone().index_add_(axis, idx, src)
def _segment_sum(src, seg, n):
    out = torch.zeros((n,) + src.shape[1:], dtype=src.dtype)
    return out.index_add_(0, seg, src)
def _pad(x, pw):
    flat = tuple(v for pair in reversed(pw) for v in pair)
    return torch.nn.functional.pad(x, flat)

kernel_name = 'interleave_layers__gqa_block_cached__dense_activation_gelu__decode'

def setup_inputs():

    _w = (lambda a: (lambda t: t.to(torch.bfloat16) if t.is_floating_point() else t)(torch.as_tensor(a)))
    def _A_setup():
        B, Sq, D = 2, 1, 512
        Hq, Hkv, Sk, Dh = 32, 32, 4096, 128
        assert Hq % Hkv == 0, (Hq, Hkv)
        return {
            "x": _w((lambda *s: torch.randn(*s, dtype=torch.bfloat16) * 0.05)(B, Sq, D)),
            "k_cache": _w((lambda *s: torch.randn(*s, dtype=torch.bfloat16) * 0.8)(B, Hkv, Sk, Dh)),
            "v_cache": _w((lambda *s: torch.randn(*s, dtype=torch.bfloat16) * 1.6)(B, Hkv, Sk, Dh)),
            "wq": _w((lambda *s: torch.randn(*s, dtype=torch.bfloat16) * 0.8)(D, Hq * Dh) * (D ** -0.5)),
            "wo": _w((lambda *s: torch.randn(*s, dtype=torch.bfloat16) * 1.6)(Hq * Dh, D) * ((Hq * Dh) ** -0.5)),
        }
    _A_in = _A_setup()

    def _B_setup():
        B, S, D, F = 2, 1, 512, 1376
        return {
            "x": _w((lambda *s: torch.randn(*s, dtype=torch.bfloat16) * 0.05)(B, S, D)),
            "w1": _w((lambda *s: torch.randn(*s, dtype=torch.bfloat16) * 0.4)(D, F) * (D ** -0.5)),
            "b1": _w((lambda *s: torch.randn(*s, dtype=torch.bfloat16) * 0.4)(F) * 0.01),
            "w2": _w((lambda *s: torch.randn(*s, dtype=torch.bfloat16) * 0.4)(F, D) * (F ** -0.5)),
            "b2": _w((lambda *s: torch.randn(*s, dtype=torch.bfloat16) * 0.4)(D) * 0.01),
        }
    _B_in = _B_setup()

    return {
        "A_x": _A_in["x"],
        "A_k_cache": _A_in["k_cache"],
        "A_v_cache": _A_in["v_cache"],
        "A_wq": _A_in["wq"],
        "A_wo": _A_in["wo"],
        "B_x": _B_in["x"],
        "B_w1": _B_in["w1"],
        "B_b1": _B_in["b1"],
        "B_w2": _B_in["w2"],
        "B_b2": _B_in["b2"],
    }

def reference(A_x, A_k_cache, A_v_cache, A_wq, A_wo, B_x, B_w1, B_b1, B_w2, B_b2):
    def _A_ref(x, k_cache, v_cache, wq, wo):
        B, Sq, D = x.shape
        Hq, Dh = 32, 128
        Hkv = k_cache.shape[1]
        rep = Hq // Hkv
        q = (lambda x, *d: x.permute(*d))((x @ wq).reshape(B, Sq, Hq, Dh), 0, 2, 1, 3)
        k = (lambda x, n, axis: torch.repeat_interleave(x, n, dim=axis))(k_cache, rep, axis=1)
        v = (lambda x, n, axis: torch.repeat_interleave(x, n, dim=axis))(v_cache, rep, axis=1)
        scores = torch.einsum("bhqd,bhkd->bhqk", q, k) * (Dh ** -0.5)
        p = _softmax(scores, axis=-1)
        o = torch.einsum("bhqk,bhkd->bhqd", p, v)
        return (lambda x, *d: x.permute(*d))(o, 0, 2, 1, 3).reshape(B, Sq, Hq * Dh) @ wo

    def _B_ref(x, w1, b1, w2, b2):
        h = torch.einsum("bsd,df->bsf", x, w1) + b1
        h = _gelu(h)
        return torch.einsum("bsf,fd->bsd", h, w2) + b2

    x = A_x
    x = x + _A_ref(_layernorm(x, axis=-1), A_k_cache, A_v_cache, A_wq, A_wo)
    x = x + _B_ref(_layernorm(x, axis=-1), B_w1, B_b1, B_w2, B_b2)
    x = x + _A_ref(_layernorm(x, axis=-1), A_k_cache, A_v_cache, A_wq, A_wo)
    x = x + _B_ref(_layernorm(x, axis=-1), B_w1, B_b1, B_w2, B_b2)
    return x
```

```asm
; @launch grid=(256,1,1) block=(256,1,1) lds=163840
.amdgcn_target "amdgcn-amd-amdhsa--gfx950"
.text
.globl interleave_layers__gqa_block_cached__dense_activation_gelu__decode_kernel
.p2align 8
.type interleave_layers__gqa_block_cached__dense_activation_gelu__decode_kernel,@function
interleave_layers__gqa_block_cached__dense_activation_gelu__decode_kernel:
    s_load_dwordx16 s[56:71], s[0:1], 0
    s_load_dwordx8 s[72:79], s[0:1], 64
    s_load_dwordx2 s[80:81], s[0:1], 96
    s_cmp_ge_u32 s2, 256
    s_cbranch_scc1 L_end
    s_getpc_b64 s[20:21]
L_pc0:
    s_mov_b32 s22, L_code_end-interleave_layers__gqa_block_cached__dense_activation_gelu__decode_kernel
    s_and_b32 s20, s20, 0xffffff00
    s_mov_b32 s23, 0x20000
    v_lshlrev_b32 v2, 4, v0
    s_lshr_b32 s24, s2, 3
    s_lshl_b32 s24, s24, 12
    buffer_load_dwordx4 v[100:103], v2, s[20:23], s24 offen
    v_lshrrev_b32 v1, 6, v0
    v_and_b32 v0, 63, v0
    v_readfirstlane_b32 s3, v1
    s_xor_b32 s7, s2, 0
    s_and_b32 s4, s2, 7
    s_lshr_b32 s5, s7, 3
    s_lshr_b32 s6, s7, 6
    s_bfe_u32 s7, s7, 0x10005
    v_and_b32 v16, 3, v0
    v_bfe_u32 v17, v0, 2, 2
    v_lshrrev_b32 v18, 4, v0
    v_lshlrev_b32 v6, 4, v16
    v_lshl_add_u32 v6, v17, 8, v6
    v_lshl_add_u32 v6, v18, 6, v6
    v_and_b32 v19, 7, v0
    v_bfe_u32 v20, v0, 3, 1
    v_lshlrev_b32 v7, 4, v19
    v_lshl_add_u32 v7, v20, 8, v7
    v_lshl_add_u32 v7, v18, 10, v7
    s_lshl_b32 s82, s7, 5
    s_lshl_b32 s83, s4, 2
    s_add_u32 s82, s82, s83
    s_add_u32 s82, s82, s6
    s_lshl_b32 s82, s82, 20
    s_and_b32 s83, s5, 3
    s_lshl_b32 s83, s83, 18
    s_add_u32 s82, s82, s83
    s_lshl_b32 s83, s3, 16
    s_add_u32 s82, s82, s83
    s_mul_i32 s84, s4, 8
    s_mul_i32 s83, s5, 1
    s_add_u32 s84, s84, s83
    s_mul_i32 s83, s3, 4
    s_add_u32 s84, s84, s83
    s_and_b32 s84, s84, 15
    s_lshl_b32 s84, s84, 12
    s_mul_i32 s85, s3, 25600
    s_add_u32 s85, s85, 61440
    s_mov_b32 s10, 0x10000
    s_mov_b32 s11, 0x20000
    s_mov_b32 m0, s85
    s_waitcnt lgkmcnt(0)
    s_add_u32 s8, s58, s82
    s_addc_u32 s9, s59, 0
    buffer_load_dwordx4 v6, s[8:11], s84 offen offset:0 nt lds
    buffer_load_dwordx4 v6, s[8:11], s84 offen offset:1024 nt lds
    buffer_load_dwordx4 v6, s[8:11], s84 offen offset:2048 nt lds
    buffer_load_dwordx4 v6, s[8:11], s84 offen offset:3072 nt lds
    s_add_u32 s86, s84, 4096
    s_and_b32 s86, s86, 0xffff
    s_add_u32 m0, s85, 4096
    s_nop 0
    buffer_load_dwordx4 v6, s[8:11], s86 offen offset:0 nt lds
    buffer_load_dwordx4 v6, s[8:11], s86 offen offset:1024 nt lds
    buffer_load_dwordx4 v6, s[8:11], s86 offen offset:2048 nt lds
    buffer_load_dwordx4 v6, s[8:11], s86 offen offset:3072 nt lds
    s_add_u32 s12, s60, s82
    s_addc_u32 s13, s61, 0
    s_mov_b32 s14, 0x10000
    s_mov_b32 s15, 0x20000
    s_add_u32 m0, s85, 12288
    s_nop 0
    buffer_load_dwordx4 v7, s[12:15], s84 offen nt lds
    s_mov_b32 s16, s80
    s_mov_b32 s17, s81
    s_mov_b32 s18, 540672
    s_mov_b32 s19, 0x20000
    s_mov_b32 s20, s56
    s_mov_b32 s21, s57
    s_mov_b32 s22, 2048
    s_mov_b32 s23, 0x20000
    s_mov_b32 s24, s62
    s_mov_b32 s25, s63
    s_mov_b32 s26, 4194304
    s_mov_b32 s27, 0x20000
    s_mov_b32 s28, s64
    s_mov_b32 s29, s65
    s_mov_b32 s30, 4194304
    s_mov_b32 s31, 0x20000
    s_mov_b32 s32, s68
    s_mov_b32 s33, s69
    s_mov_b32 s34, 1409024
    s_mov_b32 s35, 0x20000
    s_mul_i32 s83, s4, 180224
    s_add_u32 s36, s72, s83
    s_addc_u32 s37, s73, 0
    s_sub_u32 s38, 1409024, s83
    s_min_u32 s38, s38, 180224
    s_mov_b32 s39, 0x20000
    s_mov_b32 s40, s70
    s_mov_b32 s41, s71
    s_mov_b32 s42, 2752
    s_mov_b32 s43, 0x20000
    s_mov_b32 s44, s74
    s_mov_b32 s45, s75
    s_mov_b32 s46, 1024
    s_mov_b32 s47, 0x20000
    s_mov_b32 s48, s76
    s_mov_b32 s49, s77
    s_mov_b32 s50, 2048
    s_mov_b32 s51, 0x20000
    s_mov_b32 s52, s78
    s_mov_b32 s53, s79
    s_mov_b32 s54, 256
    s_mov_b32 s55, 0x20000
    s_mov_b32 s71, s84
    s_mov_b32 s72, s85
    s_mov_b32 s56, 0x00030003
    s_mov_b32 s57, 0x00030003
    s_mov_b32 s58, 0x00030003
    s_mov_b32 s59, 0
    s_mov_b32 s60, 0xffff
    s_mov_b32 s61, 0
    s_mov_b32 s62, 0xff
    s_mov_b32 s63, 0
    s_mov_b32 s66, 0x33333333
    s_mov_b32 s67, 0xcccccccc
    s_mov_b32 s68, 0
    s_mov_b32 s69, 0
    s_mov_b32 s70, 0
    s_mul_i32 s96, s4, 11
    s_add_u32 s96, s96, s5
    v_mov_b32 v64, -1
    v_mov_b32 v65, -1
    v_mov_b32 v66, -1
    v_mov_b32 v67, -1
    s_lshl_b32 s75, s2, 11
    v_lshlrev_b32 v21, 4, v0
    s_cmp_lg_u32 s3, 0
    s_cbranch_scc1 L_noclr
    buffer_store_dwordx4 v[64:67], v21, s[16:19], s75 offen sc1
    buffer_store_dwordx4 v[64:67], v21, s[16:19], s75 offen offset:1024 sc1
L_noclr:
    v_and_b32 v27, 1, v0
    v_lshrrev_b32 v83, 1, v0
    v_lshlrev_b32 v89, 4, v27
    v_lshl_add_u32 v80, v83, 13, v89
    v_lshl_add_u32 v81, v83, 10, v89
    v_mul_u32_u24 v82, 2752, v83
    v_add_u32 v82, v82, v89
    s_lshl_b32 s77, s5, 5
    s_lshl_b32 s75, s3, 8
    v_and_b32 v9, 0x1f0, v6
    v_and_b32 v28, 0x100, v9
    v_mad_u32_u24 v9, v28, 3, v9
    v_add_u32 v9, s75, v9
    s_mov_b32 s0, 0x00ff00ff
    s_mov_b32 s1, 0x00ff00ff
    v_bfe_u32 v84, v0, 2, 2
    v_cmp_eq_u32 vcc, 2, v84
    v_mov_b32 v85, 0x3f803f80
    s_mul_i32 s75, s3, 192
    s_add_u32 s75, s75, 57344
    v_cndmask_b32 v32, 0, v85, vcc
    v_mov_b32 v33, v32
    v_mov_b32 v34, v32
    v_mov_b32 v35, v32
    v_lshlrev_b32 v84, 2, v0
    v_add_u32 v84, s75, v84
    s_lshl_b32 s75, s3, 4
    s_add_u32 s75, s75, 58112
    v_bfe_u32 v85, v0, 2, 1
    v_lshrrev_b32 v86, 5, v0
    v_lshlrev_b32 v85, 3, v85
    v_lshl_add_u32 v85, v86, 2, v85
    v_add_u32 v85, s75, v85
    v_lshlrev_b32 v86, 3, v0
    v_and_b32 v87, 56, v86
    v_add_u32 v86, 57344, v86
    v_add_u32 v87, 57472, v87
    v_and_b32 v88, 8, v0
    v_add_u32 v88, 58112, v88
    s_mov_b64 exec, s[0:1]
    buffer_load_dwordx4 v[32:35], v9, s[20:23], 0 offen
    s_mov_b64 exec, -1
    s_lshl_b32 s75, s4, 5
    s_add_u32 s75, s75, s5
    s_lshl_b32 s78, s75, 8
    s_lshl_b32 s80, s4, 13
    s_lshl_b32 s75, s3, 11
    s_add_u32 s80, s80, s75
    s_lshl_b32 s75, s4, 2
    s_add_u32 s76, s75, s6
    s_add_u32 s75, s75, s3
    s_lshl_b32 s81, s75, 7
    s_add_u32 s81, s81, 196608
    s_and_b32 s95, s5, 7
    s_lshl_b32 s79, s95, 3
    s_lshl_b32 s75, s76, 7
    s_add_u32 s79, s79, s75
    s_add_u32 s79, s79, 196608
    s_lshl_b32 s83, s95, 10
    s_lshl_b32 s75, s6, 14
    s_add_u32 s83, s83, s75
    s_add_u32 s83, s83, 65536
    s_lshl_b32 s75, s4, 7
    s_add_u32 s82, s83, s75
    s_add_u32 s89, s83, 65536
    s_add_u32 s88, s82, 65536
    s_lshl_b32 s75, s76, 9
    s_lshl_b32 s95, s95, 5
    s_add_u32 s92, s75, s95
    s_lshl_b32 s95, s7, 8
    s_add_u32 s93, s75, s95
    s_add_u32 s92, s92, 524288
    s_add_u32 s93, s93, 524288
    s_lshl_b32 s85, s4, 11
    s_add_u32 s85, s85, 212992
    s_add_u32 s84, s85, s77
    s_add_u32 s91, s85, 16384
    s_add_u32 s90, s84, 16384
    s_lshl_b32 s87, s4, 10
    s_add_u32 s87, s87, 204800
    s_lshl_b32 s86, s5, 6
    s_add_u32 s86, s86, s87
    s_mov_b32 s94, 0
    v_lshlrev_b32 v24, 2, v19
    v_lshl_add_u32 v25, v20, 8, v24
    v_lshl_add_u32 v26, v20, 10, v24
    s_mov_b64 exec, s[60:61]
    s_cmp_lg_u32 s3, 0
    s_cbranch_scc1 L_noclr2
    s_mov_b64 exec, 0x303
    v_lshlrev_b32 v25, 4, v19
    v_lshl_add_u32 v25, v20, 8, v25
    buffer_store_dwordx4 v[64:67], v25, s[16:19], s92 offen sc1
    s_mov_b64 exec, s[60:61]
L_noclr2:
    buffer_load_dword v13, v26, s[20:23], s77 offen
    buffer_load_dword v15, v24, s[44:47], s77 offen
    s_lshl_b32 s75, s96, 5
    buffer_load_dword v14, v24, s[40:43], s75 offen
    s_mov_b64 exec, -1
    s_lshl_b32 s75, s5, 2
    s_add_u32 s75, s75, s3
    s_sub_u32 s75, s75, 64
    s_cbranch_scc1 L_pf_1
    s_lshl_b32 s75, s75, 16
    s_lshl_b32 s76, s4, 10
    s_add_u32 s75, s75, s76
    v_lshrrev_b32 v60, 3, v0
    v_and_b32 v61, 7, v0
    v_lshlrev_b32 v60, 13, v60
    v_lshl_add_u32 v60, v61, 7, v60
    buffer_load_dword v61, v60, s[24:27], s75 offen
L_pf_1:
    s_mov_b64 exec, 1
    buffer_load_dword v100, off, s[48:51], 0
    s_mov_b64 exec, -1
    s_add_u32 m0, s72, 8192
    s_add_u32 s73, s71, 8192
    s_and_b32 s73, s73, 0xffff
    buffer_load_dwordx4 v6, s[8:11], s73 offen offset:0 nt lds
    buffer_load_dwordx4 v6, s[8:11], s73 offen offset:1024 nt lds
    buffer_load_dwordx4 v6, s[8:11], s73 offen offset:2048 nt lds
    buffer_load_dwordx4 v6, s[8:11], s73 offen offset:3072 nt lds
    s_add_u32 s73, s71, 12288
    s_and_b32 s73, s73, 0xffff
    buffer_load_dwordx4 a[0:3], v6, s[8:11], s73 offen offset:0 nt
    buffer_load_dwordx4 a[4:7], v6, s[8:11], s73 offen offset:1024 nt
    buffer_load_dwordx4 a[8:11], v6, s[8:11], s73 offen offset:2048 nt
    buffer_load_dwordx4 a[12:15], v6, s[8:11], s73 offen offset:3072 nt
    v_lshlrev_b32 v1, 4, v0
    v_add_u32 v1, s72, v1
    s_lshl_b32 s75, s3, 12
    v_lshlrev_b32 v8, 3, v16
    v_lshl_add_u32 v8, v17, 5, v8
    v_lshl_add_u32 v10, v18, 8, v8
    v_lshl_add_u32 v8, v18, 10, v8
    v_add_u32 v8, s75, v8
    v_add_u32 v28, v16, v18
    v_and_b32 v28, 3, v28
    v_and_b32 v11, 4, v0
    v_lshlrev_b32 v11, 3, v11
    v_lshl_add_u32 v11, v28, 3, v11
    v_mov_b32 v29, 0xffff
    v_mov_b32 v30, 0xffff0000
    v_cmp_eq_u32 vcc, 1, v27
    s_nop 1
    v_cndmask_b32 v29, v29, v30, vcc
    v_cmp_eq_u32 vcc, 0, v17
    s_nop 1
    v_cndmask_b32 v2, 0, v29, vcc
    v_cmp_eq_u32 vcc, 1, v17
    s_nop 1
    v_cndmask_b32 v3, 0, v29, vcc
    v_cmp_eq_u32 vcc, 2, v17
    s_nop 1
    v_cndmask_b32 v4, 0, v29, vcc
    v_cmp_eq_u32 vcc, 3, v17
    s_nop 1
    v_cndmask_b32 v5, 0, v29, vcc
    s_add_u32 s73, s71, 16384
    s_and_b32 s73, s73, 0xffff
    buffer_load_dwordx4 a[16:19], v6, s[8:11], s73 offen offset:0 nt
    buffer_load_dwordx4 a[20:23], v6, s[8:11], s73 offen offset:1024 nt
    buffer_load_dwordx4 a[24:27], v6, s[8:11], s73 offen offset:2048 nt
    buffer_load_dwordx4 a[28:31], v6, s[8:11], s73 offen offset:3072 nt
    s_add_u32 s73, s71, 20480
    s_and_b32 s73, s73, 0xffff
    buffer_load_dwordx4 a[32:35], v6, s[8:11], s73 offen offset:0 nt
    s_cmp_lg_u32 s3, 0
    s_cbranch_scc1 L_noarr
    s_waitcnt vmcnt(14)
    s_getreg_b32 s75, hwreg(HW_REG_XCC_ID)
    s_and_b32 s75, s75, 15
    s_mul_i32 s76, s75, 6
    s_add_u32 s76, s76, 8
    s_lshl_b64 s[100:101], 1, s76
    s_cmp_lt_u32 s75, 8
    s_cselect_b64 s[100:101], s[100:101], 0
    s_or_b32 s100, s100, 1
    v_mov_b32 v98, s100
    v_mov_b32 v99, s101
    s_lshl_b32 s75, s4, 5
    v_mov_b32 v97, s75
    s_mov_b64 exec, 1
    buffer_atomic_add_x2 v[98:99], v97, s[52:55], 0 offen sc1
    s_mov_b64 exec, -1
L_noarr:
    buffer_load_dwordx4 a[36:39], v6, s[8:11], s73 offen offset:1024 nt
    buffer_load_dwordx4 a[40:43], v6, s[8:11], s73 offen offset:2048 nt
    buffer_load_dwordx4 a[44:47], v6, s[8:11], s73 offen offset:3072 nt
    s_add_u32 s73, s71, 24576
    s_and_b32 s73, s73, 0xffff
    buffer_load_dwordx4 a[48:51], v6, s[8:11], s73 offen offset:0 nt
    buffer_load_dwordx4 a[52:55], v6, s[8:11], s73 offen offset:1024 nt
    buffer_load_dwordx4 a[56:59], v6, s[8:11], s73 offen offset:2048 nt
    buffer_load_dwordx4 a[60:63], v6, s[8:11], s73 offen offset:3072 nt
    s_add_u32 s73, s71, 28672
    s_and_b32 s73, s73, 0xffff
    buffer_load_dwordx4 a[64:67], v6, s[8:11], s73 offen offset:0 nt
    buffer_load_dwordx4 a[68:71], v6, s[8:11], s73 offen offset:1024 nt
    buffer_load_dwordx4 a[72:75], v6, s[8:11], s73 offen offset:2048 nt
    s_lshl_b32 s77, s5, 5
    s_lshl_b32 s75, s3, 20
    s_lshl_b32 s76, s4, 10
    s_add_u32 s75, s75, s76
    s_add_u32 s75, s75, s77
    s_lshl_b32 s76, s3, 12
    s_add_u32 m0, s76, 0
    s_nop 0
    buffer_load_dwordx4 v80, s[24:27], s75 offen  lds
    s_add_u32 s75, s75, 262144
    s_add_u32 m0, s76, 1024
    s_nop 0
    buffer_load_dwordx4 v80, s[24:27], s75 offen  lds
    s_add_u32 s75, s75, 262144
    s_add_u32 m0, s76, 2048
    s_nop 0
    buffer_load_dwordx4 v80, s[24:27], s75 offen  lds
    s_add_u32 s75, s75, 262144
    s_add_u32 m0, s76, 3072
    s_nop 0
    buffer_load_dwordx4 v80, s[24:27], s75 offen  lds
    s_add_u32 s75, s75, 262144
    buffer_load_dwordx4 a[76:79], v6, s[8:11], s73 offen offset:3072 nt
    s_add_u32 s73, s71, 32768
    s_and_b32 s73, s73, 0xffff
    buffer_load_dwordx4 a[80:83], v6, s[8:11], s73 offen offset:0 nt
    buffer_load_dwordx4 a[84:87], v6, s[8:11], s73 offen offset:1024 nt
    buffer_load_dwordx4 a[88:91], v6, s[8:11], s73 offen offset:2048 nt
    buffer_load_dwordx4 a[92:95], v6, s[8:11], s73 offen offset:3072 nt
    s_add_u32 s73, s71, 36864
    s_and_b32 s73, s73, 0xffff
    buffer_load_dwordx4 a[96:99], v6, s[8:11], s73 offen offset:0 nt
    s_lshl_b32 s75, s5, 2
    s_add_u32 s75, s75, s3
    s_cmp_lt_u32 s75, 64
    s_cbranch_scc1 L_pf_2
    s_cmp_ge_u32 s75, 96
    s_cbranch_scc1 L_pf_3
    s_sub_u32 s75, s75, 64
    s_lshl_b32 s75, s75, 13
    v_lshlrev_b32 v60, 7, v0
    v_add_u32 v60, s75, v60
    buffer_load_dword v61, v60, s[36:39], 0 offen
    s_branch L_pf_2
L_pf_3:
    s_sub_u32 s75, s75, 96
    s_mul_i32 s75, s75, 44032
    s_mul_i32 s76, s4, 352
    s_add_u32 s75, s75, s76
    v_lshrrev_b32 v60, 2, v0
    v_mul_u32_u24 v60, 2752, v60
    v_and_b32 v61, 3, v0
    v_lshlrev_b32 v61, 7, v61
    v_min_u32 v61, 348, v61
    v_add_u32 v60, v60, v61
    buffer_load_dword v61, v60, s[32:35], s75 offen
L_pf_2:
    buffer_load_dwordx4 a[100:103], v6, s[8:11], s73 offen offset:1024 nt
    buffer_load_dwordx4 a[104:107], v6, s[8:11], s73 offen offset:2048 nt
    buffer_load_dwordx4 a[108:111], v6, s[8:11], s73 offen offset:3072 nt
    s_add_u32 s73, s71, 40960
    s_and_b32 s73, s73, 0xffff
    buffer_load_dwordx4 a[112:115], v6, s[8:11], s73 offen offset:0 nt
    buffer_load_dwordx4 a[116:119], v6, s[8:11], s73 offen offset:1024 nt
    s_waitcnt vmcnt(11)
    ds_read_b64_tr_b16 v[16:17], v8 offset:0
    ds_read_b64_tr_b16 v[18:19], v8 offset:128
    ds_read_b64_tr_b16 v[20:21], v8 offset:256
    ds_read_b64_tr_b16 v[22:23], v8 offset:384
    ds_read_b64_tr_b16 v[24:25], v8 offset:512
    ds_read_b64_tr_b16 v[26:27], v8 offset:640
    ds_read_b64_tr_b16 v[28:29], v8 offset:768
    ds_read_b64_tr_b16 v[30:31], v8 offset:896
    s_waitcnt lgkmcnt(0)
    v_mfma_f32_16x16x32_bf16 v[52:55], v[32:35], v[32:35], 0
    v_mfma_f32_16x16x32_bf16 v[36:39], v[32:35], v[16:19], 0
    v_mfma_f32_16x16x32_bf16 v[40:43], v[32:35], v[20:23], 0
    v_mfma_f32_16x16x32_bf16 v[44:47], v[32:35], v[24:27], 0
    v_mfma_f32_16x16x32_bf16 v[48:51], v[32:35], v[28:31], 0
    s_nop 3
    v_mov_b32_dpp v56, v52 quad_perm:[0,0,0,0] row_mask:0xf bank_mask:0xf
    v_add_f32_dpp v56, v53, v56 quad_perm:[1,1,1,1] row_mask:0xf bank_mask:0xf
    v_add_f32_dpp v56, v54, v56 quad_perm:[2,2,2,2] row_mask:0xf bank_mask:0xf
    v_add_f32_dpp v56, v55, v56 quad_perm:[3,3,3,3] row_mask:0xf bank_mask:0xf
    s_mov_b32 exec_lo, 0x00100001
    s_mov_b32 exec_hi, 0x11
    ds_write_b32 v85, v56
    s_mov_b32 exec_lo, -1
    s_mov_b32 exec_hi, 0xffff
    v_add_f32 v36, v36, v41
    v_add_f32 v46, v46, v51
    v_add_f32 v36, v36, v46
    ds_write_b32 v84, v36
    s_mov_b64 exec, -1
    s_waitcnt lgkmcnt(0)
    s_barrier
    s_cmp_lg_u32 s3, 0
    s_cbranch_scc1 L_skip_4
    v_mov_b32 v90, v80
    v_mov_b32 v91, v81
    v_mov_b32 v92, v82
    s_mov_b64 exec, s[60:61]
    ds_read2_b64 v[72:75], v88 offset0:0 offset1:2
    ds_read2_b64 v[76:79], v88 offset0:4 offset1:6
    ds_read2_b64 v[64:67], v86 offset0:0 offset1:24
    ds_read2_b64 v[68:71], v86 offset0:48 offset1:72
    ds_read2_b64 v[80:83], v87 offset0:0 offset1:24
    ds_read2_b64 v[84:87], v87 offset0:48 offset1:72
    s_waitcnt lgkmcnt(4)
    v_pk_add_f32 v[72:73], v[72:73], v[74:75]
    v_pk_add_f32 v[76:77], v[76:77], v[78:79]
    v_pk_add_f32 v[72:73], v[72:73], v[76:77]
    v_mul_f32 v74, 0x3b000000, v73
    v_mul_f32 v72, 0x3b000000, v72
    v_fma_f32 v72, -v74, v74, v72
    v_max_f32 v72, 0, v72
    v_add_f32 v72, 0x3727c5ac, v72
    v_rsq_f32 v76, v72
    s_waitcnt lgkmcnt(0)
    v_pk_add_f32 v[64:65], v[64:65], v[66:67]
    v_pk_add_f32 v[68:69], v[68:69], v[70:71]
    v_pk_add_f32 v[80:81], v[80:81], v[82:83]
    v_pk_add_f32 v[84:85], v[84:85], v[86:87]
    v_pk_add_f32 v[64:65], v[64:65], v[68:69]
    v_pk_add_f32 v[80:81], v[80:81], v[84:85]
    v_pk_fma_f32 v[64:65], v[80:81], v[74:75], v[64:65] op_sel_hi:[1,0,1] neg_lo:[1,0,0] neg_hi:[1,0,0]
    v_pk_mul_f32 v[64:65], v[64:65], v[76:77] op_sel_hi:[1,0]
    v_lshlrev_b32 v68, 2, v0
    v_and_b32 v68, 28, v68
    v_bfe_u32 v69, v0, 3, 1
    v_lshl_add_u32 v68, v69, 8, v68
    v_cvt_pk_bf16_f32 v64, v64, v65
    v_min_u32 v64, -2, v64
    buffer_store_dword v64, v68, s[16:19], s92 offen sc1
    s_mov_b64 exec, -1
    v_mov_b32 v81, v91
    v_mov_b32 v82, v92
L_skip_4:
    buffer_load_dwordx4 a[120:123], v6, s[8:11], s73 offen offset:2048 nt
    s_mov_b64 s[46:47], 0
    s_cmp_lg_u32 s3, 3
    s_cbranch_scc1 L_dry_ret
    s_mov_b64 s[46:47], -1
    s_branch L_att2
L_dry_back:
    s_mov_b64 s[46:47], 0
    s_waitcnt lgkmcnt(0)
L_dry_ret:
    buffer_load_dwordx4 a[124:127], v6, s[8:11], s73 offen offset:3072 nt
    s_add_u32 s73, s71, 45056
    s_and_b32 s73, s73, 0xffff
    buffer_load_dwordx4 a[128:131], v6, s[8:11], s73 offen offset:0 nt
    buffer_load_dwordx4 a[132:135], v6, s[8:11], s73 offen offset:1024 nt
    buffer_load_dwordx4 a[136:139], v6, s[8:11], s73 offen offset:2048 nt
    buffer_load_dwordx4 a[140:143], v6, s[8:11], s73 offen offset:3072 nt
    s_add_u32 s73, s71, 49152
    s_and_b32 s73, s73, 0xffff
    buffer_load_dwordx4 a[144:147], v6, s[8:11], s73 offen offset:0 nt
    s_lshl_b32 s75, s4, 5
    s_mov_b64 exec, 1
    buffer_load_dwordx2 v[94:95], off, s[52:55], s75 sc1
    s_mov_b64 exec, -1
    buffer_load_dwordx4 a[148:151], v6, s[8:11], s73 offen offset:1024 nt
    buffer_load_dwordx4 a[152:155], v6, s[8:11], s73 offen offset:2048 nt
    buffer_load_dwordx4 a[156:159], v6, s[8:11], s73 offen offset:3072 nt
    s_add_u32 s73, s71, 53248
    s_and_b32 s73, s73, 0xffff
    buffer_load_dwordx4 a[160:163], v6, s[8:11], s73 offen offset:0 nt
    buffer_load_dwordx4 a[164:167], v6, s[8:11], s73 offen offset:1024 nt
    buffer_load_dwordx4 a[168:171], v6, s[8:11], s73 offen offset:2048 nt
    buffer_load_dwordx4 a[172:175], v6, s[8:11], s73 offen offset:3072 nt
    s_add_u32 s73, s71, 57344
    s_and_b32 s73, s73, 0xffff
    buffer_load_dwordx4 a[176:179], v6, s[8:11], s73 offen offset:0 nt
    v_lshrrev_b32 v59, 1, v0
    v_and_b32 v31, 1, v0
    v_lshlrev_b32 v31, 4, v31
    v_mul_u32_u24 v30, 2752, v59
    v_add_u32 v30, v30, v31
    v_lshl_add_u32 v59, v59, 10, v31
    s_lshl_b32 s77, s5, 5
    s_lshl_b32 s76, s3, 12
    s_mul_i32 s75, s3, 352256
    s_lshl_b32 s100, s96, 5
    s_add_u32 s75, s75, s100
    s_cmp_lt_u32 s5, 11
    s_cselect_b32 s34, s34, 0
    s_add_u32 m0, s76, 32768
    s_nop 0
    buffer_load_dwordx4 v30, s[32:35], s75 offen  lds
    s_add_u32 s75, s75, 88064
    s_add_u32 m0, s76, 33792
    s_nop 0
    buffer_load_dwordx4 v30, s[32:35], s75 offen  lds
    s_add_u32 s75, s75, 88064
    s_add_u32 m0, s76, 34816
    s_nop 0
    buffer_load_dwordx4 v30, s[32:35], s75 offen  lds
    s_add_u32 s75, s75, 88064
    s_add_u32 m0, s76, 35840
    s_nop 0
    buffer_load_dwordx4 v30, s[32:35], s75 offen  lds
    s_add_u32 s75, s75, 88064
    s_cmp_eq_u32 s3, 3
    s_cbranch_scc1 L_w2_5
    s_lshl_b32 s75, s3, 16
    s_add_u32 s75, s75, s77
    v_add_u32 v59, s75, v59
    v_add_u32 v31, 0x8000, v59
    s_lshl_b32 s76, s3, 11
    s_add_u32 m0, s76, 49152
    s_nop 0
    buffer_load_dwordx4 v59, s[36:39], 0 offen  lds
    s_add_u32 m0, s76, 50176
    s_nop 0
    buffer_load_dwordx4 v31, s[36:39], 0 offen  lds
L_w2_5:
    buffer_load_dwordx4 a[180:183], v6, s[8:11], s73 offen offset:1024 nt
    buffer_load_dwordx4 a[184:187], v6, s[8:11], s73 offen offset:2048 nt
    buffer_load_dwordx4 a[188:191], v6, s[8:11], s73 offen offset:3072 nt
    s_add_u32 s73, s71, 61440
    s_and_b32 s73, s73, 0xffff
    buffer_load_dwordx4 a[192:195], v6, s[8:11], s73 offen offset:0 nt
    s_waitcnt vmcnt(16)
L_arr_7:
    v_readfirstlane_b32 s100, v94
    v_readfirstlane_b32 s101, v95
    s_nop 0
    s_and_b32 s75, s100, 0xff
    s_cmp_eq_u32 s75, 32
    s_cbranch_scc1 L_arr_ok_6
    s_sleep 16
    s_lshl_b32 s75, s4, 5
    s_mov_b64 exec, 1
    buffer_load_dwordx2 v[94:95], off, s[52:55], s75 sc1
    s_mov_b64 exec, -1
    s_add_u32 s68, s68, 8
    s_cmp_lt_u32 s68, 100000
    s_waitcnt vmcnt(0)
    s_cbranch_scc1 L_arr_7
L_arr_ok_6:
    s_getreg_b32 s75, hwreg(HW_REG_XCC_ID)
    s_and_b32 s75, s75, 15
    s_mul_i32 s76, s75, 6
    s_add_u32 s76, s76, 8
    s_lshr_b64 s[100:101], s[100:101], s76
    s_and_b32 s100, s100, 63
    s_cmp_eq_u32 s100, 32
    s_cselect_b32 s69, 1, 0
    s_cmp_lt_u32 s75, 8
    s_cselect_b32 s69, s69, 0
    buffer_load_dwordx4 a[196:199], v6, s[8:11], s73 offen offset:1024 nt
    buffer_load_dwordx4 a[200:203], v6, s[8:11], s73 offen offset:2048 nt
    buffer_load_dwordx4 a[204:207], v6, s[8:11], s73 offen offset:3072 nt
    s_mov_b32 s74, s71
    s_add_u32 m0, s72, 13184
    s_nop 0
    buffer_load_dwordx4 v7, s[12:15], s74 offen offset:128 nt lds
    s_add_u32 m0, s72, 13824
    s_nop 0
    buffer_load_dwordx4 v7, s[12:15], s74 offen offset:512 nt lds
    s_add_u32 m0, s72, 14720
    s_nop 0
    buffer_load_dwordx4 v7, s[12:15], s74 offen offset:640 nt lds
    s_add_u32 m0, s72, 16384
    s_add_u32 s74, s71, 4096
    s_and_b32 s74, s74, 0xffff
    buffer_load_dwordx4 v7, s[12:15], s74 offen offset:0 nt lds
    s_add_u32 m0, s72, 17280
    s_nop 0
    buffer_load_dwordx4 v7, s[12:15], s74 offen offset:128 nt lds
    s_add_u32 m0, s72, 17920
    s_nop 0
    buffer_load_dwordx4 v7, s[12:15], s74 offen offset:512 nt lds
    s_add_u32 m0, s72, 18816
    s_nop 0
    buffer_load_dwordx4 v7, s[12:15], s74 offen offset:640 nt lds
    s_add_u32 m0, s72, 20480
    s_add_u32 s74, s71, 8192
    s_and_b32 s74, s74, 0xffff
    buffer_load_dwordx4 v7, s[12:15], s74 offen offset:0 nt lds
    s_add_u32 m0, s72, 21376
    s_nop 0
    buffer_load_dwordx4 v7, s[12:15], s74 offen offset:128 nt lds
    s_add_u32 m0, s72, 22016
    s_nop 0
    buffer_load_dwordx4 v7, s[12:15], s74 offen offset:512 nt lds
    s_add_u32 m0, s72, 22912
    s_nop 0
    buffer_load_dwordx4 v7, s[12:15], s74 offen offset:640 nt lds
    v_and_b32 v62, 0xf0, v6
    buffer_load_dwordx4 v[96:99], v62, s[16:19], s93 offen sc1
    s_add_u32 m0, s72, 24576
    s_add_u32 s74, s71, 12288
    s_and_b32 s74, s74, 0xffff
    buffer_load_dwordx4 v7, s[12:15], s74 offen offset:0 nt lds
    buffer_load_dwordx4 a[208:211], v7, s[12:15], s74 offen offset:128 nt
    buffer_load_dwordx4 a[212:215], v7, s[12:15], s74 offen offset:512 nt
    buffer_load_dwordx4 a[216:219], v7, s[12:15], s74 offen offset:640 nt
    s_add_u32 s74, s71, 16384
    s_and_b32 s74, s74, 0xffff
    buffer_load_dwordx4 a[220:223], v7, s[12:15], s74 offen offset:0 nt
    buffer_load_dwordx4 a[224:227], v7, s[12:15], s74 offen offset:128 nt
    buffer_load_dwordx4 a[228:231], v7, s[12:15], s74 offen offset:512 nt
    buffer_load_dwordx4 a[232:235], v7, s[12:15], s74 offen offset:640 nt
    s_add_u32 s74, s71, 20480
    s_and_b32 s74, s74, 0xffff
    buffer_load_dwordx4 a[236:239], v7, s[12:15], s74 offen offset:0 nt
    buffer_load_dwordx4 a[240:243], v7, s[12:15], s74 offen offset:128 nt
    buffer_load_dwordx4 a[244:247], v7, s[12:15], s74 offen offset:512 nt
    buffer_load_dwordx4 a[248:251], v7, s[12:15], s74 offen offset:640 nt
    s_waitcnt vmcnt(12)
L_q_9:
    v_max_u32 v63, v96, v97
    v_max3_u32 v63, v63, v98, v99
    v_cmp_eq_u32 vcc, -1, v63
    s_cbranch_vccz L_q_ok_8
    buffer_load_dwordx4 v[96:99], v62, s[16:19], s93 offen sc1
    s_add_u32 s68, s68, 1
    s_cmp_lt_u32 s68, 100000
    s_waitcnt vmcnt(0)
    s_cbranch_scc1 L_q_9
L_q_ok_8:
    s_sub_u32 s92, s92, 278528
    s_sub_u32 s93, s93, 278528
    ds_read_b128 v[64:67], v1 offset:0
    ds_read_b128 v[68:71], v1 offset:1024
    ds_read_b128 v[72:75], v1 offset:2048
    ds_read_b128 v[76:79], v1 offset:3072
    ds_read_b128 v[80:83], v1 offset:4096
    ds_read_b128 v[84:87], v1 offset:5120
    ds_read_b128 v[88:91], v1 offset:6144
    ds_read_b128 v[92:95], v1 offset:7168
    v_mov_b32 v16, 0
    v_mov_b32 v17, 0
    v_mov_b32 v18, 0
    v_mov_b32 v19, 0
    v_mov_b32 v20, 0
    v_mov_b32 v21, 0
    v_mov_b32 v22, 0
    v_mov_b32 v23, 0
    v_mov_b32 v24, 0
    v_mov_b32 v25, 0
    v_mov_b32 v26, 0
    v_mov_b32 v27, 0
    v_mov_b32 v28, 0
    v_mov_b32 v29, 0
    v_mov_b32 v30, 0
    v_mov_b32 v31, 0
    v_mov_b32 v63, 0x3e0293ee
    v_mov_b32_dpp v16, v96 quad_perm:[0,1,2,3] row_mask:0xf bank_mask:0x1
    v_mov_b32_dpp v17, v97 quad_perm:[0,1,2,3] row_mask:0xf bank_mask:0x1
    v_mov_b32_dpp v18, v98 quad_perm:[0,1,2,3] row_mask:0xf bank_mask:0x1
    v_mov_b32_dpp v19, v99 quad_perm:[0,1,2,3] row_mask:0xf bank_mask:0x1
    v_mov_b32_dpp v20, v96 quad_perm:[0,1,2,3] row_mask:0xf bank_mask:0x2
    v_mov_b32_dpp v21, v97 quad_perm:[0,1,2,3] row_mask:0xf bank_mask:0x2
    v_mov_b32_dpp v22, v98 quad_perm:[0,1,2,3] row_mask:0xf bank_mask:0x2
    v_mov_b32_dpp v23, v99 quad_perm:[0,1,2,3] row_mask:0xf bank_mask:0x2
    s_waitcnt lgkmcnt(0)
    v_mfma_f32_16x16x32_bf16 v[48:51], v[16:19], v[64:67], 0
    v_mov_b32_dpp v24, v96 quad_perm:[0,1,2,3] row_mask:0xf bank_mask:0x4
    v_mov_b32_dpp v25, v97 quad_perm:[0,1,2,3] row_mask:0xf bank_mask:0x4
    v_mov_b32_dpp v26, v98 quad_perm:[0,1,2,3] row_mask:0xf bank_mask:0x4
    v_mov_b32_dpp v27, v99 quad_perm:[0,1,2,3] row_mask:0xf bank_mask:0x4
    v_mfma_f32_16x16x32_bf16 v[48:51], v[20:23], v[68:71], v[48:51]
    v_mov_b32_dpp v28, v96 quad_perm:[0,1,2,3] row_mask:0xf bank_mask:0x8
    v_mov_b32_dpp v29, v97 quad_perm:[0,1,2,3] row_mask:0xf bank_mask:0x8
    v_mov_b32_dpp v30, v98 quad_perm:[0,1,2,3] row_mask:0xf bank_mask:0x8
    v_mov_b32_dpp v31, v99 quad_perm:[0,1,2,3] row_mask:0xf bank_mask:0x8
    v_mfma_f32_16x16x32_bf16 v[48:51], v[24:27], v[72:75], v[48:51]
    s_nop 0
    v_mfma_f32_16x16x32_bf16 v[48:51], v[28:31], v[76:79], v[48:51]
    s_add_u32 s74, s71, 24576
    s_and_b32 s74, s74, 0xffff
    buffer_load_dwordx4 a[252:255], v7, s[12:15], s74 offen offset:0 nt
    v_mfma_f32_16x16x32_bf16 v[52:55], v[16:19], v[80:83], 0
    ds_read_b128 v[64:67], v1 offset:8192
    v_mfma_f32_16x16x32_bf16 v[52:55], v[20:23], v[84:87], v[52:55]
    ds_read_b128 v[68:71], v1 offset:9216
    v_mfma_f32_16x16x32_bf16 v[52:55], v[24:27], v[88:91], v[52:55]
    ds_read_b128 v[72:75], v1 offset:10240
    v_mfma_f32_16x16x32_bf16 v[52:55], v[28:31], v[92:95], v[52:55]
    ds_read_b128 v[76:79], v1 offset:11264
    buffer_load_dwordx4 v[100:103], v7, s[12:15], s74 offen offset:128 nt
    v_mfma_f32_16x16x32_bf16 v[56:59], v[16:19], a[0:3], 0
    v_mul_f32_dpp v32, v48, v63 quad_perm:[0,0,0,0] row_mask:0xf bank_mask:0xf
    ds_read_b128 v[80:83], v1 offset:12288
    v_mfma_f32_16x16x32_bf16 v[56:59], v[20:23], a[4:7], v[56:59]
    v_fmac_f32_dpp v32, v49, v63 quad_perm:[1,1,1,1] row_mask:0xf bank_mask:0xf
    v_mfma_f32_16x16x32_bf16 v[56:59], v[24:27], a[8:11], v[56:59]
    v_fmac_f32_dpp v32, v50, v63 quad_perm:[2,2,2,2] row_mask:0xf bank_mask:0xf
    v_mfma_f32_16x16x32_bf16 v[56:59], v[28:31], a[12:15], v[56:59]
    v_fmac_f32_dpp v32, v51, v63 quad_perm:[3,3,3,3] row_mask:0xf bank_mask:0xf
    buffer_load_dwordx4 v[104:107], v7, s[12:15], s74 offen offset:512 nt
    v_mfma_f32_16x16x32_bf16 v[48:51], v[16:19], a[16:19], 0
    v_mul_f32_dpp v33, v52, v63 quad_perm:[0,0,0,0] row_mask:0xf bank_mask:0xf
    ds_read_b128 v[84:87], v1 offset:13312
    v_mfma_f32_16x16x32_bf16 v[48:51], v[20:23], a[20:23], v[48:51]
    v_fmac_f32_dpp v33, v53, v63 quad_perm:[1,1,1,1] row_mask:0xf bank_mask:0xf
    v_mfma_f32_16x16x32_bf16 v[48:51], v[24:27], a[24:27], v[48:51]
    v_fmac_f32_dpp v33, v54, v63 quad_perm:[2,2,2,2] row_mask:0xf bank_mask:0xf
    v_mfma_f32_16x16x32_bf16 v[48:51], v[28:31], a[28:31], v[48:51]
    v_fmac_f32_dpp v33, v55, v63 quad_perm:[3,3,3,3] row_mask:0xf bank_mask:0xf
    buffer_load_dwordx4 v[108:111], v7, s[12:15], s74 offen offset:640 nt
    v_mfma_f32_16x16x32_bf16 v[52:55], v[16:19], a[32:35], 0
    v_mul_f32_dpp v35, v56, v63 quad_perm:[0,0,0,0] row_mask:0xf bank_mask:0xf
    ds_read_b128 v[88:91], v1 offset:14336
    v_mfma_f32_16x16x32_bf16 v[52:55], v[20:23], a[36:39], v[52:55]
    v_fmac_f32_dpp v35, v57, v63 quad_perm:[1,1,1,1] row_mask:0xf bank_mask:0xf
    v_max_f32 v60, v32, v33
    v_mfma_f32_16x16x32_bf16 v[52:55], v[24:27], a[40:43], v[52:55]
    v_fmac_f32_dpp v35, v58, v63 quad_perm:[2,2,2,2] row_mask:0xf bank_mask:0xf
    v_mfma_f32_16x16x32_bf16 v[52:55], v[28:31], a[44:47], v[52:55]
    v_fmac_f32_dpp v35, v59, v63 quad_perm:[3,3,3,3] row_mask:0xf bank_mask:0xf
    s_add_u32 s74, s71, 28672
    s_and_b32 s74, s74, 0xffff
    buffer_load_dwordx4 v[112:115], v7, s[12:15], s74 offen offset:0 nt
    s_waitcnt lgkmcnt(3)
    v_mfma_f32_16x16x32_bf16 v[56:59], v[16:19], v[64:67], 0
    v_mul_f32_dpp v36, v48, v63 quad_perm:[0,0,0,0] row_mask:0xf bank_mask:0xf
    ds_read_b128 v[92:95], v1 offset:15360
    v_mfma_f32_16x16x32_bf16 v[56:59], v[20:23], v[68:71], v[56:59]
    v_fmac_f32_dpp v36, v49, v63 quad_perm:[1,1,1,1] row_mask:0xf bank_mask:0xf
    v_mfma_f32_16x16x32_bf16 v[56:59], v[24:27], v[72:75], v[56:59]
    v_fmac_f32_dpp v36, v50, v63 quad_perm:[2,2,2,2] row_mask:0xf bank_mask:0xf
    v_mfma_f32_16x16x32_bf16 v[56:59], v[28:31], v[76:79], v[56:59]
    v_fmac_f32_dpp v36, v51, v63 quad_perm:[3,3,3,3] row_mask:0xf bank_mask:0xf
    buffer_load_dwordx4 v[116:119], v7, s[12:15], s74 offen offset:128 nt
    v_mfma_f32_16x16x32_bf16 v[48:51], v[16:19], a[48:51], 0
    v_mul_f32_dpp v37, v52, v63 quad_perm:[0,0,0,0] row_mask:0xf bank_mask:0xf
    ds_read_b128 v[64:67], v1 offset:16384
    v_mfma_f32_16x16x32_bf16 v[48:51], v[20:23], a[52:55], v[48:51]
    v_fmac_f32_dpp v37, v53, v63 quad_perm:[1,1,1,1] row_mask:0xf bank_mask:0xf
    v_max3_f32 v60, v60, v35, v36
    v_mfma_f32_16x16x32_bf16 v[48:51], v[24:27], a[56:59], v[48:51]
    v_fmac_f32_dpp v37, v54, v63 quad_perm:[2,2,2,2] row_mask:0xf bank_mask:0xf
    v_mfma_f32_16x16x32_bf16 v[48:51], v[28:31], a[60:63], v[48:51]
    v_fmac_f32_dpp v37, v55, v63 quad_perm:[3,3,3,3] row_mask:0xf bank_mask:0xf
    buffer_load_dwordx4 v[120:123], v7, s[12:15], s74 offen offset:512 nt
    v_mfma_f32_16x16x32_bf16 v[52:55], v[16:19], a[64:67], 0
    v_mul_f32_dpp v34, v56, v63 quad_perm:[0,0,0,0] row_mask:0xf bank_mask:0xf
    ds_read_b128 v[68:71], v1 offset:17408
    v_mfma_f32_16x16x32_bf16 v[52:55], v[20:23], a[68:71], v[52:55]
    v_fmac_f32_dpp v34, v57, v63 quad_perm:[1,1,1,1] row_mask:0xf bank_mask:0xf
    v_mfma_f32_16x16x32_bf16 v[52:55], v[24:27], a[72:75], v[52:55]
    v_fmac_f32_dpp v34, v58, v63 quad_perm:[2,2,2,2] row_mask:0xf bank_mask:0xf
    v_mfma_f32_16x16x32_bf16 v[52:55], v[28:31], a[76:79], v[52:55]
    v_fmac_f32_dpp v34, v59, v63 quad_perm:[3,3,3,3] row_mask:0xf bank_mask:0xf
    buffer_load_dwordx4 v[124:127], v7, s[12:15], s74 offen offset:640 nt
    v_mfma_f32_16x16x32_bf16 v[56:59], v[16:19], a[80:83], 0
    v_mul_f32_dpp v38, v48, v63 quad_perm:[0,0,0,0] row_mask:0xf bank_mask:0xf
    ds_read_b128 v[72:75], v1 offset:18432
    v_mfma_f32_16x16x32_bf16 v[56:59], v[20:23], a[84:87], v[56:59]
    v_fmac_f32_dpp v38, v49, v63 quad_perm:[1,1,1,1] row_mask:0xf bank_mask:0xf
    v_max3_f32 v60, v60, v37, v34
    v_mfma_f32_16x16x32_bf16 v[56:59], v[24:27], a[88:91], v[56:59]
    v_fmac_f32_dpp v38, v50, v63 quad_perm:[2,2,2,2] row_mask:0xf bank_mask:0xf
    v_mfma_f32_16x16x32_bf16 v[56:59], v[28:31], a[92:95], v[56:59]
    v_fmac_f32_dpp v38, v51, v63 quad_perm:[3,3,3,3] row_mask:0xf bank_mask:0xf
    s_add_u32 s74, s71, 32768
    s_and_b32 s74, s74, 0xffff
    buffer_load_dwordx4 v[128:131], v7, s[12:15], s74 offen offset:0 nt
    v_mfma_f32_16x16x32_bf16 v[48:51], v[16:19], a[96:99], 0
    v_mul_f32_dpp v39, v52, v63 quad_perm:[0,0,0,0] row_mask:0xf bank_mask:0xf
    ds_read_b128 v[76:79], v1 offset:19456
    v_mfma_f32_16x16x32_bf16 v[48:51], v[20:23], a[100:103], v[48:51]
    v_fmac_f32_dpp v39, v53, v63 quad_perm:[1,1,1,1] row_mask:0xf bank_mask:0xf
    v_mfma_f32_16x16x32_bf16 v[48:51], v[24:27], a[104:107], v[48:51]
    v_fmac_f32_dpp v39, v54, v63 quad_perm:[2,2,2,2] row_mask:0xf bank_mask:0xf
    v_mfma_f32_16x16x32_bf16 v[48:51], v[28:31], a[108:111], v[48:51]
    v_fmac_f32_dpp v39, v55, v63 quad_perm:[3,3,3,3] row_mask:0xf bank_mask:0xf
    buffer_load_dwordx4 v[132:135], v7, s[12:15], s74 offen offset:128 nt
    v_mfma_f32_16x16x32_bf16 v[52:55], v[16:19], a[112:115], 0
    v_mul_f32_dpp v40, v56, v63 quad_perm:[0,0,0,0] row_mask:0xf bank_mask:0xf
    v_max3_f32 v60, v60, v38, v39
    v_mfma_f32_16x16x32_bf16 v[52:55], v[20:23], a[116:119], v[52:55]
    v_fmac_f32_dpp v40, v57, v63 quad_perm:[1,1,1,1] row_mask:0xf bank_mask:0xf
    v_mfma_f32_16x16x32_bf16 v[52:55], v[24:27], a[120:123], v[52:55]
    v_fmac_f32_dpp v40, v58, v63 quad_perm:[2,2,2,2] row_mask:0xf bank_mask:0xf
    v_mfma_f32_16x16x32_bf16 v[52:55], v[28:31], a[124:127], v[52:55]
    v_fmac_f32_dpp v40, v59, v63 quad_perm:[3,3,3,3] row_mask:0xf bank_mask:0xf
    buffer_load_dwordx4 v[136:139], v7, s[12:15], s74 offen offset:512 nt
    v_mfma_f32_16x16x32_bf16 v[56:59], v[16:19], a[128:131], 0
    v_mul_f32_dpp v41, v48, v63 quad_perm:[0,0,0,0] row_mask:0xf bank_mask:0xf
    v_mfma_f32_16x16x32_bf16 v[56:59], v[20:23], a[132:135], v[56:59]
    v_fmac_f32_dpp v41, v49, v63 quad_perm:[1,1,1,1] row_mask:0xf bank_mask:0xf
    v_mfma_f32_16x16x32_bf16 v[56:59], v[24:27], a[136:139], v[56:59]
    v_fmac_f32_dpp v41, v50, v63 quad_perm:[2,2,2,2] row_mask:0xf bank_mask:0xf
    v_mfma_f32_16x16x32_bf16 v[56:59], v[28:31], a[140:143], v[56:59]
    v_fmac_f32_dpp v41, v51, v63 quad_perm:[3,3,3,3] row_mask:0xf bank_mask:0xf
    buffer_load_dwordx4 v[140:143], v7, s[12:15], s74 offen offset:640 nt
    v_mfma_f32_16x16x32_bf16 v[48:51], v[16:19], a[144:147], 0
    v_mul_f32_dpp v42, v52, v63 quad_perm:[0,0,0,0] row_mask:0xf bank_mask:0xf
    v_max3_f32 v60, v60, v40, v41
    v_mfma_f32_16x16x32_bf16 v[48:51], v[20:23], a[148:151], v[48:51]
    v_fmac_f32_dpp v42, v53, v63 quad_perm:[1,1,1,1] row_mask:0xf bank_mask:0xf
    v_mfma_f32_16x16x32_bf16 v[48:51], v[24:27], a[152:155], v[48:51]
    v_fmac_f32_dpp v42, v54, v63 quad_perm:[2,2,2,2] row_mask:0xf bank_mask:0xf
    v_mfma_f32_16x16x32_bf16 v[48:51], v[28:31], a[156:159], v[48:51]
    v_fmac_f32_dpp v42, v55, v63 quad_perm:[3,3,3,3] row_mask:0xf bank_mask:0xf
    s_add_u32 s74, s71, 36864
    s_and_b32 s74, s74, 0xffff
    buffer_load_dwordx4 v[144:147], v7, s[12:15], s74 offen offset:0 nt
    v_mfma_f32_16x16x32_bf16 v[52:55], v[16:19], a[160:163], 0
    v_mul_f32_dpp v43, v56, v63 quad_perm:[0,0,0,0] row_mask:0xf bank_mask:0xf
    v_mfma_f32_16x16x32_bf16 v[52:55], v[20:23], a[164:167], v[52:55]
    v_fmac_f32_dpp v43, v57, v63 quad_perm:[1,1,1,1] row_mask:0xf bank_mask:0xf
    v_mfma_f32_16x16x32_bf16 v[52:55], v[24:27], a[168:171], v[52:55]
    v_fmac_f32_dpp v43, v58, v63 quad_perm:[2,2,2,2] row_mask:0xf bank_mask:0xf
    v_mfma_f32_16x16x32_bf16 v[52:55], v[28:31], a[172:175], v[52:55]
    v_fmac_f32_dpp v43, v59, v63 quad_perm:[3,3,3,3] row_mask:0xf bank_mask:0xf
    buffer_load_dwordx4 v[148:151], v7, s[12:15], s74 offen offset:128 nt
    v_mfma_f32_16x16x32_bf16 v[56:59], v[16:19], a[176:179], 0
    v_mul_f32_dpp v44, v48, v63 quad_perm:[0,0,0,0] row_mask:0xf bank_mask:0xf
    v_max3_f32 v60, v60, v42, v43
    v_mfma_f32_16x16x32_bf16 v[56:59], v[20:23], a[180:183], v[56:59]
    v_fmac_f32_dpp v44, v49, v63 quad_perm:[1,1,1,1] row_mask:0xf bank_mask:0xf
    v_mfma_f32_16x16x32_bf16 v[56:59], v[24:27], a[184:187], v[56:59]
    v_fmac_f32_dpp v44, v50, v63 quad_perm:[2,2,2,2] row_mask:0xf bank_mask:0xf
    v_mfma_f32_16x16x32_bf16 v[56:59], v[28:31], a[188:191], v[56:59]
    v_fmac_f32_dpp v44, v51, v63 quad_perm:[3,3,3,3] row_mask:0xf bank_mask:0xf
    buffer_load_dwordx4 v[152:155], v7, s[12:15], s74 offen offset:512 nt
    v_mfma_f32_16x16x32_bf16 v[48:51], v[16:19], a[192:195], 0
    v_mul_f32_dpp v45, v52, v63 quad_perm:[0,0,0,0] row_mask:0xf bank_mask:0xf
    v_mfma_f32_16x16x32_bf16 v[48:51], v[20:23], a[196:199], v[48:51]
    v_fmac_f32_dpp v45, v53, v63 quad_perm:[1,1,1,1] row_mask:0xf bank_mask:0xf
    v_mfma_f32_16x16x32_bf16 v[48:51], v[24:27], a[200:203], v[48:51]
    v_fmac_f32_dpp v45, v54, v63 quad_perm:[2,2,2,2] row_mask:0xf bank_mask:0xf
    v_mfma_f32_16x16x32_bf16 v[48:51], v[28:31], a[204:207], v[48:51]
    v_fmac_f32_dpp v45, v55, v63 quad_perm:[3,3,3,3] row_mask:0xf bank_mask:0xf
    buffer_load_dwordx4 v[156:159], v7, s[12:15], s74 offen offset:640 nt
    v_mul_f32_dpp v46, v56, v63 quad_perm:[0,0,0,0] row_mask:0xf bank_mask:0xf
    v_fmac_f32_dpp v46, v57, v63 quad_perm:[1,1,1,1] row_mask:0xf bank_mask:0xf
    v_fmac_f32_dpp v46, v58, v63 quad_perm:[2,2,2,2] row_mask:0xf bank_mask:0xf
    v_fmac_f32_dpp v46, v59, v63 quad_perm:[3,3,3,3] row_mask:0xf bank_mask:0xf
    v_max3_f32 v60, v60, v44, v45
    v_max_f32 v60, v60, v46
    v_mul_f32_dpp v47, v48, v63 quad_perm:[0,0,0,0] row_mask:0xf bank_mask:0xf
    v_fmac_f32_dpp v47, v49, v63 quad_perm:[1,1,1,1] row_mask:0xf bank_mask:0xf
    v_fmac_f32_dpp v47, v50, v63 quad_perm:[2,2,2,2] row_mask:0xf bank_mask:0xf
    v_fmac_f32_dpp v47, v51, v63 quad_perm:[3,3,3,3] row_mask:0xf bank_mask:0xf
    v_max_f32 v60, v60, v47
    v_lshrrev_b32 v56, 5, v0
    v_and_b32 v57, 1, v0
    v_max_f32_dpp v60, v60, v60 row_ror:4 row_mask:0xf bank_mask:0xf
    v_lshlrev_b32 v56, 9, v56
    v_lshl_add_u32 v56, v57, 8, v56
    v_max_f32_dpp v60, v60, v60 row_ror:8 row_mask:0xf bank_mask:0xf
    v_and_b32 v57, 28, v0
    v_lshl_add_u32 v56, v57, 2, v56
    v_max_f32_dpp v60, v60, v60 row_bcast:15 row_mask:0xa bank_mask:0xf
    s_lshl_b32 s76, s3, 10
    s_add_u32 s76, s76, 57344
    v_max_f32_dpp v60, v60, v60 row_bcast:31 row_mask:0xc bank_mask:0xf
    v_add_u32 v56, s76, v56
    v_readlane_b32 s75, v60, 63
    v_and_b32 v57, 48, v0
    v_and_b32 v58, 3, v0
    v_mov_b32 v62, s75
    v_sub_f32 v28, v32, v62
    v_sub_f32 v29, v33, v62
    v_exp_f32 v28, v28
    v_exp_f32 v29, v29
    v_cvt_pk_bf16_f32 v32, v28, v28
    v_mov_b32 v63, v28
    v_cvt_pk_bf16_f32 v33, v29, v29
    v_and_b32_dpp v16, v32, v2 row_ror:14 row_mask:0xf bank_mask:0xf
    v_and_b32_dpp v17, v32, v3 row_ror:2 row_mask:0xf bank_mask:0xf
    v_and_b32_dpp v18, v32, v4 row_ror:6 row_mask:0xf bank_mask:0xf
    v_and_b32_dpp v19, v32, v5 row_ror:10 row_mask:0xf bank_mask:0xf
    v_add_f32 v63, v63, v29
    v_and_b32_dpp v20, v32, v2 row_ror:6 row_mask:0xf bank_mask:0xf
    v_and_b32_dpp v21, v32, v3 row_ror:10 row_mask:0xf bank_mask:0xf
    v_and_b32_dpp v22, v32, v4 row_ror:14 row_mask:0xf bank_mask:0xf
    v_and_b32_dpp v23, v32, v5 row_ror:2 row_mask:0xf bank_mask:0xf
    s_waitcnt lgkmcnt(4)
    v_mfma_f32_16x16x32_bf16 v[48:51], v[80:83], v[16:19], 0
    v_and_b32_dpp v24, v33, v2 row_ror:14 row_mask:0xf bank_mask:0xf
    v_and_b32_dpp v25, v33, v3 row_ror:2 row_mask:0xf bank_mask:0xf
    v_sub_f32 v28, v34, v62
    ds_read_b128 v[80:83], v1 offset:20480
    v_mfma_f32_16x16x32_bf16 v[52:55], v[84:87], v[16:19], 0
    v_and_b32_dpp v26, v33, v4 row_ror:6 row_mask:0xf bank_mask:0xf
    v_and_b32_dpp v27, v33, v5 row_ror:10 row_mask:0xf bank_mask:0xf
    v_exp_f32 v28, v28
    ds_read_b128 v[84:87], v1 offset:21504
    v_mfma_f32_16x16x32_bf16 v[48:51], v[88:91], v[20:23], v[48:51]
    v_and_b32_dpp v16, v33, v2 row_ror:6 row_mask:0xf bank_mask:0xf
    v_and_b32_dpp v17, v33, v3 row_ror:10 row_mask:0xf bank_mask:0xf
    v_cvt_pk_bf16_f32 v34, v28, v28
    ds_read_b128 v[88:91], v1 offset:22528
    v_mfma_f32_16x16x32_bf16 v[52:55], v[92:95], v[20:23], v[52:55]
    v_and_b32_dpp v18, v33, v4 row_ror:14 row_mask:0xf bank_mask:0xf
    v_and_b32_dpp v19, v33, v5 row_ror:2 row_mask:0xf bank_mask:0xf
    v_add_f32 v63, v63, v28
    ds_read_b128 v[92:95], v1 offset:23552
    s_waitcnt lgkmcnt(4)
    v_mfma_f32_16x16x32_bf16 v[48:51], v[64:67], v[24:27], v[48:51]
    v_and_b32_dpp v20, v34, v2 row_ror:14 row_mask:0xf bank_mask:0xf
    v_and_b32_dpp v21, v34, v3 row_ror:2 row_mask:0xf bank_mask:0xf
    v_sub_f32 v29, v35, v62
    s_waitcnt vmcnt(27)
    ds_read_b128 v[64:67], v1 offset:24576
    v_mfma_f32_16x16x32_bf16 v[52:55], v[68:71], v[24:27], v[52:55]
    v_and_b32_dpp v22, v34, v4 row_ror:6 row_mask:0xf bank_mask:0xf
    v_and_b32_dpp v23, v34, v5 row_ror:10 row_mask:0xf bank_mask:0xf
    v_exp_f32 v29, v29
    v_mfma_f32_16x16x32_bf16 v[48:51], v[72:75], v[16:19], v[48:51]
    v_and_b32_dpp v24, v34, v2 row_ror:6 row_mask:0xf bank_mask:0xf
    v_and_b32_dpp v25, v34, v3 row_ror:10 row_mask:0xf bank_mask:0xf
    v_cvt_pk_bf16_f32 v35, v29, v29
    v_mfma_f32_16x16x32_bf16 v[52:55], v[76:79], v[16:19], v[52:55]
    v_and_b32_dpp v26, v34, v4 row_ror:14 row_mask:0xf bank_mask:0xf
    v_and_b32_dpp v27, v34, v5 row_ror:2 row_mask:0xf bank_mask:0xf
    v_add_f32 v63, v63, v29
    s_waitcnt lgkmcnt(1)
    v_mfma_f32_16x16x32_bf16 v[48:51], v[80:83], v[20:23], v[48:51]
    v_and_b32_dpp v16, v35, v2 row_ror:14 row_mask:0xf bank_mask:0xf
    v_and_b32_dpp v17, v35, v3 row_ror:2 row_mask:0xf bank_mask:0xf
    v_sub_f32 v28, v36, v62
    v_mfma_f32_16x16x32_bf16 v[52:55], v[84:87], v[20:23], v[52:55]
    v_and_b32_dpp v18, v35, v4 row_ror:6 row_mask:0xf bank_mask:0xf
    v_and_b32_dpp v19, v35, v5 row_ror:10 row_mask:0xf bank_mask:0xf
    v_exp_f32 v28, v28
    v_mfma_f32_16x16x32_bf16 v[48:51], v[88:91], v[24:27], v[48:51]
    v_and_b32_dpp v20, v35, v2 row_ror:6 row_mask:0xf bank_mask:0xf
    v_and_b32_dpp v21, v35, v3 row_ror:10 row_mask:0xf bank_mask:0xf
    v_cvt_pk_bf16_f32 v36, v28, v28
    v_mfma_f32_16x16x32_bf16 v[52:55], v[92:95], v[24:27], v[52:55]
    v_and_b32_dpp v22, v35, v4 row_ror:14 row_mask:0xf bank_mask:0xf
    v_and_b32_dpp v23, v35, v5 row_ror:2 row_mask:0xf bank_mask:0xf
    v_add_f32 v63, v63, v28
    s_waitcnt lgkmcnt(0)
    v_mfma_f32_16x16x32_bf16 v[48:51], v[64:67], v[16:19], v[48:51]
    v_and_b32_dpp v24, v36, v2 row_ror:14 row_mask:0xf bank_mask:0xf
    v_and_b32_dpp v25, v36, v3 row_ror:2 row_mask:0xf bank_mask:0xf
    v_sub_f32 v29, v37, v62
    s_waitcnt vmcnt(26)
    v_mfma_f32_16x16x32_bf16 v[52:55], a[208:211], v[16:19], v[52:55]
    v_and_b32_dpp v26, v36, v4 row_ror:6 row_mask:0xf bank_mask:0xf
    v_and_b32_dpp v27, v36, v5 row_ror:10 row_mask:0xf bank_mask:0xf
    v_exp_f32 v29, v29
    s_waitcnt vmcnt(25)
    v_mfma_f32_16x16x32_bf16 v[48:51], a[212:215], v[20:23], v[48:51]
    v_and_b32_dpp v16, v36, v2 row_ror:6 row_mask:0xf bank_mask:0xf
    v_and_b32_dpp v17, v36, v3 row_ror:10 row_mask:0xf bank_mask:0xf
    v_cvt_pk_bf16_f32 v37, v29, v29
    s_waitcnt vmcnt(24)
    v_mfma_f32_16x16x32_bf16 v[52:55], a[216:219], v[20:23], v[52:55]
    v_and_b32_dpp v18, v36, v4 row_ror:14 row_mask:0xf bank_mask:0xf
    v_and_b32_dpp v19, v36, v5 row_ror:2 row_mask:0xf bank_mask:0xf
    v_add_f32 v63, v63, v29
    s_waitcnt vmcnt(23)
    v_mfma_f32_16x16x32_bf16 v[48:51], a[220:223], v[24:27], v[48:51]
    v_and_b32_dpp v20, v37, v2 row_ror:14 row_mask:0xf bank_mask:0xf
    v_and_b32_dpp v21, v37, v3 row_ror:2 row_mask:0xf bank_mask:0xf
    v_sub_f32 v28, v38, v62
    v_lshl_add_u32 v57, v58, 2, v57
    s_waitcnt vmcnt(22)
    v_mfma_f32_16x16x32_bf16 v[52:55], a[224:227], v[24:27], v[52:55]
    v_and_b32_dpp v22, v37, v4 row_ror:6 row_mask:0xf bank_mask:0xf
    v_and_b32_dpp v23, v37, v5 row_ror:10 row_mask:0xf bank_mask:0xf
    v_exp_f32 v28, v28
    s_waitcnt vmcnt(21)
    v_mfma_f32_16x16x32_bf16 v[48:51], a[228:231], v[16:19], v[48:51]
    v_and_b32_dpp v24, v37, v2 row_ror:6 row_mask:0xf bank_mask:0xf
    v_and_b32_dpp v25, v37, v3 row_ror:10 row_mask:0xf bank_mask:0xf
    v_cvt_pk_bf16_f32 v38, v28, v28
    s_waitcnt vmcnt(20)
    v_mfma_f32_16x16x32_bf16 v[52:55], a[232:235], v[16:19], v[52:55]
    v_and_b32_dpp v26, v37, v4 row_ror:14 row_mask:0xf bank_mask:0xf
    v_and_b32_dpp v27, v37, v5 row_ror:2 row_mask:0xf bank_mask:0xf
    v_add_f32 v63, v63, v28
    s_waitcnt vmcnt(19)
    v_mfma_f32_16x16x32_bf16 v[48:51], a[236:239], v[20:23], v[48:51]
    v_and_b32_dpp v16, v38, v2 row_ror:14 row_mask:0xf bank_mask:0xf
    v_and_b32_dpp v17, v38, v3 row_ror:2 row_mask:0xf bank_mask:0xf
    v_sub_f32 v29, v39, v62
    v_bfe_u32 v58, v0, 2, 2
    s_waitcnt vmcnt(18)
    v_mfma_f32_16x16x32_bf16 v[52:55], a[240:243], v[20:23], v[52:55]
    v_and_b32_dpp v18, v38, v4 row_ror:6 row_mask:0xf bank_mask:0xf
    v_and_b32_dpp v19, v38, v5 row_ror:10 row_mask:0xf bank_mask:0xf
    v_exp_f32 v29, v29
    s_waitcnt vmcnt(17)
    v_mfma_f32_16x16x32_bf16 v[48:51], a[244:247], v[24:27], v[48:51]
    v_and_b32_dpp v20, v38, v2 row_ror:6 row_mask:0xf bank_mask:0xf
    v_and_b32_dpp v21, v38, v3 row_ror:10 row_mask:0xf bank_mask:0xf
    v_cvt_pk_bf16_f32 v39, v29, v29
    s_waitcnt vmcnt(16)
    v_mfma_f32_16x16x32_bf16 v[52:55], a[248:251], v[24:27], v[52:55]
    v_and_b32_dpp v22, v38, v4 row_ror:14 row_mask:0xf bank_mask:0xf
    v_and_b32_dpp v23, v38, v5 row_ror:2 row_mask:0xf bank_mask:0xf
    v_add_f32 v63, v63, v29
    s_add_u32 s74, s71, 40960
    s_and_b32 s74, s74, 0xffff
    buffer_load_dwordx4 v[160:163], v7, s[12:15], s74 offen offset:0 nt
    buffer_load_dwordx4 v[164:167], v7, s[12:15], s74 offen offset:128 nt
    buffer_load_dwordx4 v[168:171], v7, s[12:15], s74 offen offset:512 nt
    buffer_load_dwordx4 v[172:175], v7, s[12:15], s74 offen offset:640 nt
    s_getpc_b64 s[20:21]
L_pc:
    s_add_u32 s20, s20, L_chain-L_pc
    s_addc_u32 s21, s21, 0
    s_mov_b32 s22, L_code_end-L_chain
    s_and_b32 s20, s20, 0xffffffc0
    s_lshl_b32 s75, s5, 2
    s_add_u32 s75, s75, s3
    s_lshl_b32 s75, s75, 12
    v_lshlrev_b32 v59, 6, v0
    buffer_load_dword v61, v59, s[20:23], s75 offen
    s_waitcnt vmcnt(20)
    v_mfma_f32_16x16x32_bf16 v[48:51], a[252:255], v[16:19], v[48:51]
    v_and_b32_dpp v24, v39, v2 row_ror:14 row_mask:0xf bank_mask:0xf
    v_and_b32_dpp v25, v39, v3 row_ror:2 row_mask:0xf bank_mask:0xf
    v_sub_f32 v28, v40, v62
    v_add_u32 v57, v57, v58
    s_waitcnt vmcnt(19)
    v_mfma_f32_16x16x32_bf16 v[52:55], v[100:103], v[16:19], v[52:55]
    v_and_b32_dpp v26, v39, v4 row_ror:6 row_mask:0xf bank_mask:0xf
    v_and_b32_dpp v27, v39, v5 row_ror:10 row_mask:0xf bank_mask:0xf
    v_exp_f32 v28, v28
    s_waitcnt vmcnt(18)
    v_mfma_f32_16x16x32_bf16 v[48:51], v[104:107], v[20:23], v[48:51]
    v_and_b32_dpp v16, v39, v2 row_ror:6 row_mask:0xf bank_mask:0xf
    v_and_b32_dpp v17, v39, v3 row_ror:10 row_mask:0xf bank_mask:0xf
    v_cvt_pk_bf16_f32 v40, v28, v28
    s_waitcnt vmcnt(17)
    v_mfma_f32_16x16x32_bf16 v[52:55], v[108:111], v[20:23], v[52:55]
    v_and_b32_dpp v18, v39, v4 row_ror:14 row_mask:0xf bank_mask:0xf
    v_and_b32_dpp v19, v39, v5 row_ror:2 row_mask:0xf bank_mask:0xf
    v_add_f32 v63, v63, v28
    s_add_u32 s74, s71, 45056
    s_and_b32 s74, s74, 0xffff
    buffer_load_dwordx4 v[176:179], v7, s[12:15], s74 offen offset:0 nt
    buffer_load_dwordx4 v[180:183], v7, s[12:15], s74 offen offset:128 nt
    buffer_load_dwordx4 v[184:187], v7, s[12:15], s74 offen offset:512 nt
    buffer_load_dwordx4 v[188:191], v7, s[12:15], s74 offen offset:640 nt
    v_lshlrev_b32 v97, 5, v0
    s_mov_b64 exec, s[62:63]
    buffer_load_dword v98, v97, s[52:55], 0 offen sc1
    s_mov_b64 exec, -1
    s_waitcnt vmcnt(21)
    v_mfma_f32_16x16x32_bf16 v[48:51], v[112:115], v[24:27], v[48:51]
    v_and_b32_dpp v20, v40, v2 row_ror:14 row_mask:0xf bank_mask:0xf
    v_and_b32_dpp v21, v40, v3 row_ror:2 row_mask:0xf bank_mask:0xf
    v_sub_f32 v29, v41, v62
    v_lshlrev_b32 v57, 2, v57
    s_waitcnt vmcnt(20)
    v_mfma_f32_16x16x32_bf16 v[52:55], v[116:119], v[24:27], v[52:55]
    v_and_b32_dpp v22, v40, v4 row_ror:6 row_mask:0xf bank_mask:0xf
    v_and_b32_dpp v23, v40, v5 row_ror:10 row_mask:0xf bank_mask:0xf
    v_exp_f32 v29, v29
    s_waitcnt vmcnt(19)
    v_mfma_f32_16x16x32_bf16 v[48:51], v[120:123], v[16:19], v[48:51]
    v_and_b32_dpp v24, v40, v2 row_ror:6 row_mask:0xf bank_mask:0xf
    v_and_b32_dpp v25, v40, v3 row_ror:10 row_mask:0xf bank_mask:0xf
    v_cvt_pk_bf16_f32 v41, v29, v29
    s_waitcnt vmcnt(18)
    v_mfma_f32_16x16x32_bf16 v[52:55], v[124:127], v[16:19], v[52:55]
    v_and_b32_dpp v26, v40, v4 row_ror:14 row_mask:0xf bank_mask:0xf
    v_and_b32_dpp v27, v40, v5 row_ror:2 row_mask:0xf bank_mask:0xf
    v_add_f32 v63, v63, v29
    s_add_u32 s74, s71, 49152
    s_and_b32 s74, s74, 0xffff
    buffer_load_dwordx4 v[192:195], v7, s[12:15], s74 offen offset:0 nt
    buffer_load_dwordx4 v[196:199], v7, s[12:15], s74 offen offset:128 nt
    buffer_load_dwordx4 v[200:203], v7, s[12:15], s74 offen offset:512 nt
    buffer_load_dwordx4 v[204:207], v7, s[12:15], s74 offen offset:640 nt
    s_waitcnt vmcnt(21)
    v_mfma_f32_16x16x32_bf16 v[48:51], v[128:131], v[20:23], v[48:51]
    v_and_b32_dpp v16, v41, v2 row_ror:14 row_mask:0xf bank_mask:0xf
    v_and_b32_dpp v17, v41, v3 row_ror:2 row_mask:0xf bank_mask:0xf
    v_sub_f32 v28, v42, v62
    v_add_u32 v57, 57344, v57
    s_waitcnt vmcnt(20)
    v_mfma_f32_16x16x32_bf16 v[52:55], v[132:135], v[20:23], v[52:55]
    v_and_b32_dpp v18, v41, v4 row_ror:6 row_mask:0xf bank_mask:0xf
    v_and_b32_dpp v19, v41, v5 row_ror:10 row_mask:0xf bank_mask:0xf
    v_exp_f32 v28, v28
    s_waitcnt vmcnt(19)
    v_mfma_f32_16x16x32_bf16 v[48:51], v[136:139], v[24:27], v[48:51]
    v_and_b32_dpp v20, v41, v2 row_ror:6 row_mask:0xf bank_mask:0xf
    v_and_b32_dpp v21, v41, v3 row_ror:10 row_mask:0xf bank_mask:0xf
    v_cvt_pk_bf16_f32 v42, v28, v28
    s_waitcnt vmcnt(18)
    v_mfma_f32_16x16x32_bf16 v[52:55], v[140:143], v[24:27], v[52:55]
    v_and_b32_dpp v22, v41, v4 row_ror:14 row_mask:0xf bank_mask:0xf
    v_and_b32_dpp v23, v41, v5 row_ror:2 row_mask:0xf bank_mask:0xf
    v_add_f32 v63, v63, v28
    s_add_u32 s74, s71, 53248
    s_and_b32 s74, s74, 0xffff
    buffer_load_dwordx4 v[208:211], v7, s[12:15], s74 offen offset:0 nt
    buffer_load_dwordx4 v[212:215], v7, s[12:15], s74 offen offset:128 nt
    buffer_load_dwordx4 v[216:219], v7, s[12:15], s74 offen offset:512 nt
    buffer_load_dwordx4 v[220:223], v7, s[12:15], s74 offen offset:640 nt
    s_waitcnt vmcnt(21)
    v_mfma_f32_16x16x32_bf16 v[48:51], v[144:147], v[16:19], v[48:51]
    v_and_b32_dpp v24, v42, v2 row_ror:14 row_mask:0xf bank_mask:0xf
    v_and_b32_dpp v25, v42, v3 row_ror:2 row_mask:0xf bank_mask:0xf
    v_sub_f32 v29, v43, v62
    s_lshl_b32 s76, s3, 3
    s_add_u32 s76, s76, 56832
    v_mov_b32 v58, s76
    s_waitcnt vmcnt(20)
    v_mfma_f32_16x16x32_bf16 v[52:55], v[148:151], v[16:19], v[52:55]
    v_and_b32_dpp v26, v42, v4 row_ror:6 row_mask:0xf bank_mask:0xf
    v_and_b32_dpp v27, v42, v5 row_ror:10 row_mask:0xf bank_mask:0xf
    v_exp_f32 v29, v29
    s_waitcnt vmcnt(19)
    v_mfma_f32_16x16x32_bf16 v[48:51], v[152:155], v[20:23], v[48:51]
    v_and_b32_dpp v16, v42, v2 row_ror:6 row_mask:0xf bank_mask:0xf
    v_and_b32_dpp v17, v42, v3 row_ror:10 row_mask:0xf bank_mask:0xf
    v_cvt_pk_bf16_f32 v43, v29, v29
    s_waitcnt vmcnt(18)
    v_mfma_f32_16x16x32_bf16 v[52:55], v[156:159], v[20:23], v[52:55]
    v_and_b32_dpp v18, v42, v4 row_ror:14 row_mask:0xf bank_mask:0xf
    v_and_b32_dpp v19, v42, v5 row_ror:2 row_mask:0xf bank_mask:0xf
    v_add_f32 v63, v63, v29
    s_add_u32 s74, s71, 57344
    s_and_b32 s74, s74, 0xffff
    buffer_load_dwordx4 v[224:227], v7, s[12:15], s74 offen offset:0 nt
    buffer_load_dwordx4 v[228:231], v7, s[12:15], s74 offen offset:128 nt
    buffer_load_dwordx4 v[232:235], v7, s[12:15], s74 offen offset:512 nt
    buffer_load_dwordx4 v[236:239], v7, s[12:15], s74 offen offset:640 nt
    s_waitcnt vmcnt(21)
    v_mfma_f32_16x16x32_bf16 v[48:51], v[160:163], v[24:27], v[48:51]
    v_and_b32_dpp v20, v43, v2 row_ror:14 row_mask:0xf bank_mask:0xf
    v_and_b32_dpp v21, v43, v3 row_ror:2 row_mask:0xf bank_mask:0xf
    v_sub_f32 v28, v44, v62
    s_waitcnt vmcnt(20)
    v_mfma_f32_16x16x32_bf16 v[52:55], v[164:167], v[24:27], v[52:55]
    v_and_b32_dpp v22, v43, v4 row_ror:6 row_mask:0xf bank_mask:0xf
    v_and_b32_dpp v23, v43, v5 row_ror:10 row_mask:0xf bank_mask:0xf
    v_exp_f32 v28, v28
    s_waitcnt vmcnt(19)
    v_mfma_f32_16x16x32_bf16 v[48:51], v[168:171], v[16:19], v[48:51]
    v_and_b32_dpp v24, v43, v2 row_ror:6 row_mask:0xf bank_mask:0xf
    v_and_b32_dpp v25, v43, v3 row_ror:10 row_mask:0xf bank_mask:0xf
    v_cvt_pk_bf16_f32 v44, v28, v28
    s_waitcnt vmcnt(18)
    v_mfma_f32_16x16x32_bf16 v[52:55], v[172:175], v[16:19], v[52:55]
    v_and_b32_dpp v26, v43, v4 row_ror:14 row_mask:0xf bank_mask:0xf
    v_and_b32_dpp v27, v43, v5 row_ror:2 row_mask:0xf bank_mask:0xf
    v_add_f32 v63, v63, v28
    s_add_u32 s74, s71, 61440
    s_and_b32 s74, s74, 0xffff
    buffer_load_dwordx4 v[240:243], v7, s[12:15], s74 offen offset:0 nt
    buffer_load_dwordx4 v[244:247], v7, s[12:15], s74 offen offset:128 nt
    buffer_load_dwordx4 v[248:251], v7, s[12:15], s74 offen offset:512 nt
    buffer_load_dwordx4 v[252:255], v7, s[12:15], s74 offen offset:640 nt
    v_lshrrev_b32 v59, 1, v0
    v_lshlrev_b32 v59, 10, v59
    v_and_b32 v31, 1, v0
    v_lshl_add_u32 v59, v31, 4, v59
    s_lshl_b32 s77, s5, 5
    s_lshl_b32 s75, s4, 19
    s_lshl_b32 s76, s3, 17
    s_add_u32 s75, s75, s76
    s_add_u32 s75, s75, s77
    s_lshl_b32 s95, s3, 12
    s_add_u32 m0, s95, 16384
    s_nop 0
    buffer_load_dwordx4 v59, s[28:31], s75 offen  lds
    s_add_u32 s75, s75, 32768
    s_add_u32 m0, s95, 17408
    s_nop 0
    buffer_load_dwordx4 v59, s[28:31], s75 offen  lds
    s_add_u32 s75, s75, 32768
    s_add_u32 m0, s95, 18432
    s_nop 0
    buffer_load_dwordx4 v59, s[28:31], s75 offen  lds
    s_add_u32 s75, s75, 32768
    s_add_u32 m0, s95, 19456
    s_nop 0
    buffer_load_dwordx4 v59, s[28:31], s75 offen  lds
    s_add_u32 s75, s75, 32768
    s_waitcnt vmcnt(24)
    v_mfma_f32_16x16x32_bf16 v[48:51], v[176:179], v[20:23], v[48:51]
    v_and_b32_dpp v16, v44, v2 row_ror:14 row_mask:0xf bank_mask:0xf
    v_and_b32_dpp v17, v44, v3 row_ror:2 row_mask:0xf bank_mask:0xf
    v_sub_f32 v29, v45, v62
    s_waitcnt vmcnt(23)
    v_mfma_f32_16x16x32_bf16 v[52:55], v[180:183], v[20:23], v[52:55]
    v_and_b32_dpp v18, v44, v4 row_ror:6 row_mask:0xf bank_mask:0xf
    v_and_b32_dpp v19, v44, v5 row_ror:10 row_mask:0xf bank_mask:0xf
    v_exp_f32 v29, v29
    s_waitcnt vmcnt(22)
    v_mfma_f32_16x16x32_bf16 v[48:51], v[184:187], v[24:27], v[48:51]
    v_and_b32_dpp v20, v44, v2 row_ror:6 row_mask:0xf bank_mask:0xf
    v_and_b32_dpp v21, v44, v3 row_ror:10 row_mask:0xf bank_mask:0xf
    v_cvt_pk_bf16_f32 v45, v29, v29
    s_waitcnt vmcnt(21)
    v_mfma_f32_16x16x32_bf16 v[52:55], v[188:191], v[24:27], v[52:55]
    v_and_b32_dpp v22, v44, v4 row_ror:14 row_mask:0xf bank_mask:0xf
    v_and_b32_dpp v23, v44, v5 row_ror:2 row_mask:0xf bank_mask:0xf
    v_add_f32 v63, v63, v29
    s_sub_u32 s75, s3, 1
    s_cmp_gt_u32 s75, 1
    s_cbranch_scc1 L_np_10
    s_xor_b32 s76, s4, 2
    s_and_b32 s76, s76, 6
    s_add_u32 s76, s76, s75
    s_lshl_b32 s76, s76, 13
    s_lshl_b32 s77, s5, 8
    s_add_u32 s76, s76, s77
    s_add_u32 s76, s76, 0
    s_waitcnt lgkmcnt(0)
    s_memtime s[100:101]
    s_load_dword s77, s[16:17], s76
    s_waitcnt lgkmcnt(0)
    s_memtime s[98:99]
    s_lshl_b32 s75, s75, 2
    s_add_u32 s75, s75, 56896
    v_mov_b32 v31, s75
    s_waitcnt lgkmcnt(0)
    s_sub_u32 s100, s98, s100
    v_mov_b32 v59, s100
    ds_write_b32 v31, v59
L_np_10:
    s_waitcnt vmcnt(19)
    v_mfma_f32_16x16x32_bf16 v[48:51], v[192:195], v[16:19], v[48:51]
    v_and_b32_dpp v24, v45, v2 row_ror:14 row_mask:0xf bank_mask:0xf
    v_and_b32_dpp v25, v45, v3 row_ror:2 row_mask:0xf bank_mask:0xf
    v_sub_f32 v28, v46, v62
    s_waitcnt vmcnt(18)
    v_mfma_f32_16x16x32_bf16 v[52:55], v[196:199], v[16:19], v[52:55]
    v_and_b32_dpp v26, v45, v4 row_ror:6 row_mask:0xf bank_mask:0xf
    v_and_b32_dpp v27, v45, v5 row_ror:10 row_mask:0xf bank_mask:0xf
    v_exp_f32 v28, v28
    s_waitcnt vmcnt(17)
    v_mfma_f32_16x16x32_bf16 v[48:51], v[200:203], v[20:23], v[48:51]
    v_and_b32_dpp v16, v45, v2 row_ror:6 row_mask:0xf bank_mask:0xf
    v_and_b32_dpp v17, v45, v3 row_ror:10 row_mask:0xf bank_mask:0xf
    v_cvt_pk_bf16_f32 v46, v28, v28
    s_waitcnt vmcnt(16)
    v_mfma_f32_16x16x32_bf16 v[52:55], v[204:207], v[20:23], v[52:55]
    v_and_b32_dpp v18, v45, v4 row_ror:14 row_mask:0xf bank_mask:0xf
    v_and_b32_dpp v19, v45, v5 row_ror:2 row_mask:0xf bank_mask:0xf
    v_add_f32 v63, v63, v28
    s_sub_u32 s75, s3, 1
    s_cmp_gt_u32 s75, 1
    s_cbranch_scc1 L_np_11
    s_xor_b32 s76, s4, 2
    s_and_b32 s76, s76, 6
    s_add_u32 s76, s76, s75
    s_lshl_b32 s76, s76, 13
    s_lshl_b32 s77, s5, 8
    s_add_u32 s76, s76, s77
    s_add_u32 s76, s76, 128
    s_waitcnt lgkmcnt(0)
    s_memtime s[100:101]
    s_load_dword s77, s[16:17], s76
    s_waitcnt lgkmcnt(0)
    s_memtime s[98:99]
    s_lshl_b32 s75, s75, 2
    s_add_u32 s75, s75, 56896
    v_mov_b32 v31, s75
    s_waitcnt lgkmcnt(0)
    s_sub_u32 s100, s98, s100
    v_mov_b32 v59, s100
    ds_min_u32 v31, v59
L_np_11:
    s_waitcnt vmcnt(15)
    v_mfma_f32_16x16x32_bf16 v[48:51], v[208:211], v[24:27], v[48:51]
    v_and_b32_dpp v20, v46, v2 row_ror:14 row_mask:0xf bank_mask:0xf
    v_and_b32_dpp v21, v46, v3 row_ror:2 row_mask:0xf bank_mask:0xf
    v_sub_f32 v29, v47, v62
    s_waitcnt vmcnt(14)
    v_mfma_f32_16x16x32_bf16 v[52:55], v[212:215], v[24:27], v[52:55]
    v_and_b32_dpp v22, v46, v4 row_ror:6 row_mask:0xf bank_mask:0xf
    v_and_b32_dpp v23, v46, v5 row_ror:10 row_mask:0xf bank_mask:0xf
    v_exp_f32 v29, v29
    s_waitcnt vmcnt(13)
    v_mfma_f32_16x16x32_bf16 v[48:51], v[216:219], v[16:19], v[48:51]
    v_and_b32_dpp v24, v46, v2 row_ror:6 row_mask:0xf bank_mask:0xf
    v_and_b32_dpp v25, v46, v3 row_ror:10 row_mask:0xf bank_mask:0xf
    v_cvt_pk_bf16_f32 v47, v29, v29
    s_waitcnt vmcnt(12)
    v_mfma_f32_16x16x32_bf16 v[52:55], v[220:223], v[16:19], v[52:55]
    v_and_b32_dpp v26, v46, v4 row_ror:14 row_mask:0xf bank_mask:0xf
    v_and_b32_dpp v27, v46, v5 row_ror:2 row_mask:0xf bank_mask:0xf
    v_add_f32 v63, v63, v29
    s_mov_b64 exec, s[62:63]
L_all_13:
    v_and_b32 v99, 0xff, v98
    v_cmp_ne_u32 vcc, 32, v99
    s_cbranch_vccz L_all_ok_12
    s_sleep 16
    buffer_load_dword v98, v97, s[52:55], 0 offen sc1
    s_add_u32 s68, s68, 8
    s_cmp_lt_u32 s68, 100000
    s_waitcnt vmcnt(0)
    s_cbranch_scc1 L_all_13
L_all_ok_12:
    s_mov_b64 exec, -1
    s_waitcnt vmcnt(11)
    v_mfma_f32_16x16x32_bf16 v[48:51], v[224:227], v[20:23], v[48:51]
    v_and_b32_dpp v16, v47, v2 row_ror:14 row_mask:0xf bank_mask:0xf
    v_and_b32_dpp v17, v47, v3 row_ror:2 row_mask:0xf bank_mask:0xf
    v_add_f32_dpp v63, v63, v63 row_ror:4 row_mask:0xf bank_mask:0xf
    s_waitcnt vmcnt(10)
    v_mfma_f32_16x16x32_bf16 v[52:55], v[228:231], v[20:23], v[52:55]
    v_and_b32_dpp v18, v47, v4 row_ror:6 row_mask:0xf bank_mask:0xf
    v_and_b32_dpp v19, v47, v5 row_ror:10 row_mask:0xf bank_mask:0xf
    s_waitcnt vmcnt(9)
    v_mfma_f32_16x16x32_bf16 v[48:51], v[232:235], v[24:27], v[48:51]
    v_and_b32_dpp v20, v47, v2 row_ror:6 row_mask:0xf bank_mask:0xf
    v_and_b32_dpp v21, v47, v3 row_ror:10 row_mask:0xf bank_mask:0xf
    v_add_f32_dpp v63, v63, v63 row_ror:8 row_mask:0xf bank_mask:0xf
    s_waitcnt vmcnt(8)
    v_mfma_f32_16x16x32_bf16 v[52:55], v[236:239], v[24:27], v[52:55]
    v_and_b32_dpp v22, v47, v4 row_ror:14 row_mask:0xf bank_mask:0xf
    v_and_b32_dpp v23, v47, v5 row_ror:2 row_mask:0xf bank_mask:0xf
    v_lshlrev_b32 v31, 7, v0
    s_mov_b64 exec, s[60:61]
    buffer_load_dword v61, v31, s[16:19], s80 offen sc1
    buffer_load_dword v61, off, s[16:19], s81 sc1
    s_mov_b64 exec, -1
    s_waitcnt vmcnt(9)
    v_mfma_f32_16x16x32_bf16 v[48:51], v[240:243], v[16:19], v[48:51]
    v_add_f32_dpp v63, v63, v63 row_bcast:15 row_mask:0xa bank_mask:0xf
    s_waitcnt vmcnt(8)
    v_mfma_f32_16x16x32_bf16 v[52:55], v[244:247], v[16:19], v[52:55]
    s_waitcnt vmcnt(7)
    v_mfma_f32_16x16x32_bf16 v[48:51], v[248:251], v[20:23], v[48:51]
    v_add_f32_dpp v63, v63, v63 row_bcast:31 row_mask:0xc bank_mask:0xf
    s_waitcnt vmcnt(6)
    v_mfma_f32_16x16x32_bf16 v[52:55], v[252:255], v[20:23], v[52:55]
L_chain:
    s_mov_b32 exec_lo, 0
    s_brev_b32 exec_hi, 1
    ds_write_b64 v58, v[62:63]
    v_mov_b32 v26, 56832
    s_mov_b64 exec, s[66:67]
    ds_write_b128 v56, v[48:51]
    s_nop 0
    ds_write_b128 v56, v[52:55] offset:128
    s_mov_b64 exec, -1
L_chain2:
    v_mov_b32 v26, 56832
    v_lshlrev_b32 v27, 2, v0
    v_mov_b32 v29, 0
    s_cmp_lg_u32 s3, 0
    s_waitcnt lgkmcnt(0)
    s_barrier
    s_cbranch_scc1 L_S2w
    ds_read_b128 v[64:67], v26
    ds_read_b128 v[68:71], v26 offset:16
    ds_read2st64_b32 v[72:73], v57 offset0:0 offset1:1
    ds_read2st64_b32 v[74:75], v57 offset0:2 offset1:3
    ds_read2st64_b32 v[76:77], v57 offset0:4 offset1:5
    ds_read2st64_b32 v[78:79], v57 offset0:6 offset1:7
    ds_read2st64_b32 v[80:81], v57 offset0:8 offset1:9
    ds_read2st64_b32 v[82:83], v57 offset0:10 offset1:11
    ds_read2st64_b32 v[84:85], v57 offset0:12 offset1:13
    ds_read2st64_b32 v[86:87], v57 offset0:14 offset1:15
    s_waitcnt lgkmcnt(8)
    v_max3_f32 v88, v64, v66, v68
    v_max_f32 v88, v88, v70
    v_sub_f32 v64, v64, v88
    v_sub_f32 v66, v66, v88
    v_sub_f32 v68, v68, v88
    v_sub_f32 v70, v70, v88
    v_exp_f32 v64, v64
    v_exp_f32 v66, v66
    v_exp_f32 v68, v68
    v_exp_f32 v70, v70
    s_cmp_eq_u32 s69, 0
    s_waitcnt lgkmcnt(0)
    v_pk_add_f32 v[72:73], v[72:73], v[74:75]
    v_pk_add_f32 v[76:77], v[76:77], v[78:79]
    v_pk_add_f32 v[80:81], v[80:81], v[82:83]
    v_pk_add_f32 v[84:85], v[84:85], v[86:87]
    v_pk_mul_f32 v[90:91], v[72:73], v[64:65] op_sel_hi:[1,0]
    v_mul_f32 v89, v64, v65
    v_pk_fma_f32 v[90:91], v[76:77], v[66:67], v[90:91] op_sel_hi:[1,0,1]
    v_fmac_f32 v89, v66, v67
    v_pk_fma_f32 v[90:91], v[80:81], v[68:69], v[90:91] op_sel_hi:[1,0,1]
    v_fmac_f32 v89, v68, v69
    v_pk_fma_f32 v[90:91], v[84:85], v[70:71], v[90:91] op_sel_hi:[1,0,1]
    v_fmac_f32 v89, v70, v71
    v_cvt_pk_bf16_f32 v90, v90, v91
    v_min_u32 v88, -2, v88
    v_min_u32 v90, -2, v90
    v_min_u32 v89, -2, v89
    s_cbranch_scc1 L_slow_14
    buffer_store_dword v90, v27, s[16:19], s78 offen
    s_mov_b64 exec, 1
    buffer_store_dwordx2 v[88:89], v29, s[16:19], s79 offen
    s_mov_b64 exec, -1
L_back_15:
L_S2:
    v_mov_b32 v72, 0
    v_mov_b32 v73, 0
    s_lshl_b32 s75, s3, 7
    s_add_u32 s75, s75, 55296
    v_and_b32 v80, 15, v0
    v_lshrrev_b32 v81, 5, v0
    v_lshlrev_b32 v80, 2, v80
    v_lshl_add_u32 v80, v81, 6, v80
    v_add_u32 v80, s75, v80
    v_lshlrev_b32 v81, 4, v0
    v_add_u32 v82, 55296, v81
    v_mov_b32 v83, 56896
    s_mov_b64 exec, s[0:1]
    buffer_load_dwordx2 v[72:73], v11, s[16:19], s81 offen sc1
    s_mov_b64 exec, -1
    buffer_load_dwordx4 v[32:35], v6, s[16:19], s80 offen sc1
    buffer_load_dwordx4 v[36:39], v6, s[16:19], s80 offen offset:1024 sc1
    s_waitcnt vmcnt(3)
    ds_read_b64_tr_b16 v[16:17], v8 offset:16384
    ds_read_b64_tr_b16 v[18:19], v8 offset:16512
    ds_read_b64_tr_b16 v[20:21], v8 offset:16640
    ds_read_b64_tr_b16 v[22:23], v8 offset:16768
    ds_read_b64_tr_b16 v[24:25], v8 offset:16896
    ds_read_b64_tr_b16 v[26:27], v8 offset:17024
    ds_read_b64_tr_b16 v[28:29], v8 offset:17152
    ds_read_b64_tr_b16 v[30:31], v8 offset:17280
L_poll_16:
    s_mov_b64 exec, s[0:1]
    buffer_load_dwordx2 v[72:73], v11, s[16:19], s81 offen sc1
    s_mov_b64 exec, -1
    buffer_load_dwordx4 v[32:35], v6, s[16:19], s80 offen sc1
    buffer_load_dwordx4 v[36:39], v6, s[16:19], s80 offen offset:1024 sc1
    s_add_u32 s68, s68, 1
    s_cmp_lt_u32 s68, 100000
    s_cselect_b64 s[64:65], -1, 0
    s_waitcnt vmcnt(3)
    v_max_u32 v74, v32, v33
    v_max3_u32 v74, v74, v34, v35
    v_max3_u32 v74, v74, v36, v37
    v_max3_u32 v74, v74, v38, v39
    v_max3_u32 v74, v74, v72, v73
    v_cmp_eq_u32 vcc, -1, v74
    s_and_b64 vcc, vcc, s[64:65]
    s_cbranch_scc1 L_poll_16
    s_waitcnt lgkmcnt(0)
    v_mfma_f32_16x16x32_bf16 v[40:43], v[32:35], v[16:19], 0
    v_max_f32_dpp v74, v72, v72 quad_perm:[1,0,3,2] row_mask:0xf bank_mask:0xf
    v_mfma_f32_16x16x32_bf16 v[44:47], v[32:35], v[20:23], 0
    s_nop 0
    v_max_f32_dpp v74, v74, v74 quad_perm:[2,3,0,1] row_mask:0xf bank_mask:0xf
    v_mfma_f32_16x16x32_bf16 v[48:51], v[32:35], v[24:27], 0
    v_sub_f32 v75, v72, v74
    v_mfma_f32_16x16x32_bf16 v[52:55], v[32:35], v[28:31], 0
    v_exp_f32 v75, v75
    v_mfma_f32_16x16x32_bf16 v[56:59], v[36:39], v[16:19], 0
    v_mul_f32 v76, v75, v73
    v_mfma_f32_16x16x32_bf16 v[60:63], v[36:39], v[20:23], 0
    s_nop 0
    v_add_f32_dpp v76, v76, v76 quad_perm:[1,0,3,2] row_mask:0xf bank_mask:0xf
    v_mfma_f32_16x16x32_bf16 v[64:67], v[36:39], v[24:27], 0
    s_nop 0
    v_add_f32_dpp v76, v76, v76 quad_perm:[2,3,0,1] row_mask:0xf bank_mask:0xf
    v_mfma_f32_16x16x32_bf16 v[68:71], v[36:39], v[28:31], 0
    v_rcp_f32 v76, v76
    s_nop 0
    v_mul_f32 v75, v75, v76
    v_add_f32 v40, v40, v45
    v_add_f32 v50, v50, v55
    v_add_f32 v40, v40, v50
    v_mul_f32_dpp v78, v75, v40 row_newbcast:0 row_mask:0xf bank_mask:0xf
    v_add_f32 v56, v56, v61
    v_add_f32 v66, v66, v71
    v_add_f32 v56, v56, v66
    v_mul_f32_dpp v79, v75, v56 row_newbcast:4 row_mask:0xf bank_mask:0xf
    s_nop 1
    v_permlane32_swap_b32 v78, v79
    v_add_f32 v78, v78, v79
    v_mov_b32 v79, v78
    s_nop 1
    v_permlane16_swap_b32 v78, v79
    v_add_f32 v78, v78, v79
    ds_write_b32 v80, v78
    s_cmp_lg_u32 s3, 0
    s_waitcnt vmcnt(0)
    s_waitcnt lgkmcnt(0)
    s_barrier
    s_cbranch_scc1 L_S3
    s_mov_b64 exec, s[62:63]
    ds_read_b128 v[64:67], v82 offset:0
    ds_read_b128 v[68:71], v82 offset:128
    ds_read_b128 v[72:75], v82 offset:256
    ds_read_b128 v[76:79], v82 offset:384
    ds_read_b64 v[84:85], v83
    s_add_u32 s75, s82, 8192
    s_waitcnt lgkmcnt(3)
    v_pk_add_f32 v[64:65], v[64:65], v[68:69]
    v_pk_add_f32 v[66:67], v[66:67], v[70:71]
    s_waitcnt lgkmcnt(1)
    v_pk_add_f32 v[72:73], v[72:73], v[76:77]
    v_pk_add_f32 v[74:75], v[74:75], v[78:79]
    v_pk_add_f32 v[64:65], v[64:65], v[72:73]
    v_pk_add_f32 v[66:67], v[66:67], v[74:75]
    v_min_u32 v64, -2, v64
    v_min_u32 v65, -2, v65
    v_min_u32 v66, -2, v66
    v_min_u32 v67, -2, v67
    buffer_store_dwordx4 v[64:67], v81, s[16:19], s82 offen sc1
    buffer_store_dwordx4 v[64:67], v81, s[16:19], s75 offen sc1
    s_mov_b64 exec, -1
    s_waitcnt lgkmcnt(0)
    v_readfirstlane_b32 s77, v84
    v_readfirstlane_b32 s76, v85
    s_nop 0
    s_cmp_lt_u32 s76, s77
    s_cselect_b32 s94, 8192, 0
L_S3:
    ds_read_b64_tr_b16 v[16:17], v8 offset:32768
    ds_read_b64_tr_b16 v[18:19], v8 offset:32896
    ds_read_b64_tr_b16 v[20:21], v8 offset:33024
    ds_read_b64_tr_b16 v[22:23], v8 offset:33152
    ds_read_b64_tr_b16 v[24:25], v8 offset:33280
    ds_read_b64_tr_b16 v[26:27], v8 offset:33408
    ds_read_b64_tr_b16 v[28:29], v8 offset:33536
    ds_read_b64_tr_b16 v[30:31], v8 offset:33664
    v_bfe_u32 v84, v0, 2, 2
    v_cmp_eq_u32 vcc, 2, v84
    v_mov_b32 v85, 0x3f803f80
    s_mul_i32 s75, s3, 192
    s_add_u32 s75, s75, 55808
    v_cndmask_b32 v32, 0, v85, vcc
    v_mov_b32 v33, v32
    v_mov_b32 v34, v32
    v_mov_b32 v35, v32
    s_mov_b64 exec, s[0:1]
    buffer_load_dwordx4 v[32:35], v9, s[16:19], s85 offen sc1
    s_mov_b64 exec, -1
    v_lshlrev_b32 v84, 2, v0
    v_add_u32 v84, s75, v84
    s_lshl_b32 s75, s3, 4
    s_add_u32 s75, s75, 56576
    v_bfe_u32 v85, v0, 2, 1
    v_lshrrev_b32 v86, 5, v0
    v_lshlrev_b32 v85, 3, v85
    v_lshl_add_u32 v85, v86, 2, v85
    v_add_u32 v85, s75, v85
    v_lshlrev_b32 v86, 3, v0
    v_and_b32 v87, 56, v86
    v_add_u32 v86, 55808, v86
    v_add_u32 v87, 55936, v87
    v_and_b32 v88, 8, v0
    v_add_u32 v88, 56576, v88
    s_sub_u32 s75, s3, 1
    s_cmp_gt_u32 s75, 1
    s_cbranch_scc1 L_np_17
    s_xor_b32 s76, s4, 4
    s_and_b32 s76, s76, 6
    s_add_u32 s76, s76, s75
    s_lshl_b32 s76, s76, 13
    s_lshl_b32 s77, s5, 8
    s_add_u32 s76, s76, s77
    s_add_u32 s76, s76, 0
    s_waitcnt lgkmcnt(0)
    s_memtime s[100:101]
    s_load_dword s77, s[16:17], s76
    s_waitcnt lgkmcnt(0)
    s_memtime s[98:99]
    s_lshl_b32 s75, s75, 2
    s_add_u32 s75, s75, 56896
    v_mov_b32 v90, s75
    s_waitcnt lgkmcnt(0)
    s_sub_u32 s100, s98, s100
    v_mov_b32 v91, s100
    ds_min_u32 v90, v91
L_np_17:
    s_cmp_lg_u32 s3, 0
    s_cbranch_scc1 L_S4
    s_mov_b64 exec, s[60:61]
    v_lshlrev_b32 v82, 3, v0
    v_lshlrev_b32 v80, 16, v13
    v_and_b32 v81, 0xffff0000, v13
    v_lshlrev_b32 v83, 2, v0
    v_and_b32 v83, 28, v83
    v_bfe_u32 v89, v0, 3, 1
    v_lshl_add_u32 v83, v89, 10, v83
    s_add_u32 s75, s83, s94
    s_sleep 4
    buffer_load_dwordx2 v[64:65], v82, s[16:19], s75 offen offset:0 sc1
    buffer_load_dwordx2 v[66:67], v82, s[16:19], s75 offen offset:128 sc1
    buffer_load_dwordx2 v[68:69], v82, s[16:19], s75 offen offset:256 sc1
    buffer_load_dwordx2 v[70:71], v82, s[16:19], s75 offen offset:384 sc1
    buffer_load_dwordx2 v[72:73], v82, s[16:19], s75 offen offset:512 sc1
    buffer_load_dwordx2 v[74:75], v82, s[16:19], s75 offen offset:640 sc1
    buffer_load_dwordx2 v[76:77], v82, s[16:19], s75 offen offset:768 sc1
    buffer_load_dwordx2 v[78:79], v82, s[16:19], s75 offen offset:896 sc1
    s_sleep 2
    buffer_load_dwordx2 v[64:65], v82, s[16:19], s75 offen offset:0 sc1
    buffer_load_dwordx2 v[66:67], v82, s[16:19], s75 offen offset:128 sc1
    buffer_load_dwordx2 v[68:69], v82, s[16:19], s75 offen offset:256 sc1
    buffer_load_dwordx2 v[70:71], v82, s[16:19], s75 offen offset:384 sc1
    buffer_load_dwordx2 v[72:73], v82, s[16:19], s75 offen offset:512 sc1
    buffer_load_dwordx2 v[74:75], v82, s[16:19], s75 offen offset:640 sc1
    buffer_load_dwordx2 v[76:77], v82, s[16:19], s75 offen offset:768 sc1
    buffer_load_dwordx2 v[78:79], v82, s[16:19], s75 offen offset:896 sc1
    s_sleep 2
L_poll_18:
    buffer_load_dwordx2 v[64:65], v82, s[16:19], s75 offen offset:0 sc1
    buffer_load_dwordx2 v[66:67], v82, s[16:19], s75 offen offset:128 sc1
    buffer_load_dwordx2 v[68:69], v82, s[16:19], s75 offen offset:256 sc1
    buffer_load_dwordx2 v[70:71], v82, s[16:19], s75 offen offset:384 sc1
    buffer_load_dwordx2 v[72:73], v82, s[16:19], s75 offen offset:512 sc1
    buffer_load_dwordx2 v[74:75], v82, s[16:19], s75 offen offset:640 sc1
    buffer_load_dwordx2 v[76:77], v82, s[16:19], s75 offen offset:768 sc1
    buffer_load_dwordx2 v[78:79], v82, s[16:19], s75 offen offset:896 sc1
    s_add_u32 s68, s68, 1
    s_waitcnt vmcnt(16)
    v_pk_add_f32 v[90:91], v[64:65], v[66:67]
    v_pk_add_f32 v[92:93], v[68:69], v[70:71]
    v_pk_add_f32 v[94:95], v[72:73], v[74:75]
    v_pk_add_f32 v[96:97], v[76:77], v[78:79]
    v_pk_add_f32 v[90:91], v[90:91], v[92:93]
    v_pk_add_f32 v[94:95], v[94:95], v[96:97]
    v_pk_add_f32 v[90:91], v[90:91], v[80:81]
    v_pk_add_f32 v[90:91], v[90:91], v[94:95]
    s_cmp_eq_u32 s69, 0
    v_cmp_u_f32 vcc, v90, v91
    s_cbranch_vccnz L_exact_20
L_ok_19:
    v_cvt_pk_bf16_f32 v13, v90, v91
    v_min_u32 v90, -2, v13
    s_cbranch_scc1 L_slow_21
    buffer_store_dword v90, v83, s[16:19], s84 offen
L_back_22:
    s_mov_b64 exec, -1
L_S4:
    s_cmp_ge_u32 s5, 11
    s_cbranch_scc1 L_S5
    s_barrier
    s_mov_b64 exec, s[0:1]
    buffer_load_dwordx4 v[32:35], v9, s[16:19], s85 offen sc1
    s_sleep 1
L_poll_23:
    buffer_load_dwordx4 v[32:35], v9, s[16:19], s85 offen sc1
    s_add_u32 s68, s68, 1
    s_cmp_lt_u32 s68, 100000
    s_cselect_b64 s[64:65], -1, 0
    s_waitcnt vmcnt(1)
    v_max_u32 v63, v32, v33
    v_max3_u32 v63, v63, v34, v35
    v_cmp_eq_u32 vcc, -1, v63
    s_and_b64 vcc, vcc, s[64:65]
    s_cbranch_scc1 L_poll_23
    s_mov_b64 exec, -1
    s_waitcnt lgkmcnt(0)
    v_mfma_f32_16x16x32_bf16 v[52:55], v[32:35], v[32:35], 0
    v_mfma_f32_16x16x32_bf16 v[36:39], v[32:35], v[16:19], 0
    v_mfma_f32_16x16x32_bf16 v[40:43], v[32:35], v[20:23], 0
    v_mfma_f32_16x16x32_bf16 v[44:47], v[32:35], v[24:27], 0
    v_mfma_f32_16x16x32_bf16 v[48:51], v[32:35], v[28:31], 0
    s_nop 3
    v_mov_b32_dpp v56, v52 quad_perm:[0,0,0,0] row_mask:0xf bank_mask:0xf
    v_add_f32_dpp v56, v53, v56 quad_perm:[1,1,1,1] row_mask:0xf bank_mask:0xf
    v_add_f32_dpp v56, v54, v56 quad_perm:[2,2,2,2] row_mask:0xf bank_mask:0xf
    v_add_f32_dpp v56, v55, v56 quad_perm:[3,3,3,3] row_mask:0xf bank_mask:0xf
    s_mov_b32 exec_lo, 0x00100001
    s_mov_b32 exec_hi, 0x11
    ds_write_b32 v85, v56
    s_mov_b32 exec_lo, -1
    s_mov_b32 exec_hi, 0xffff
    v_add_f32 v36, v36, v41
    v_add_f32 v46, v46, v51
    v_add_f32 v36, v36, v46
    ds_write_b32 v84, v36
    s_mov_b64 exec, -1
    s_waitcnt lgkmcnt(0)
    s_barrier
    s_cmp_lg_u32 s3, 0
    s_cbranch_scc1 L_S7
    s_mov_b64 exec, s[60:61]
    s_waitcnt vmcnt(0)
    s_cmp_lt_u32 s96, 86
    s_cselect_b32 s95, -1, 0
    v_lshlrev_b32 v92, 16, v14
    v_and_b32 v93, 0xffff0000, v14
    v_mov_b32 v94, 0xbdd2d3e8
    v_mov_b32 v96, 0xc0135761
    v_and_b32 v98, 3, v0
    v_lshlrev_b32 v98, 2, v98
    v_and_b32 v99, 4, v0
    v_lshl_add_u32 v98, v99, 3, v98
    v_and_b32 v99, 8, v0
    v_lshl_add_u32 v98, v99, 1, v98
    ds_read2_b64 v[72:75], v88 offset0:0 offset1:2
    ds_read2_b64 v[76:79], v88 offset0:4 offset1:6
    ds_read2_b64 v[64:67], v86 offset0:0 offset1:24
    ds_read2_b64 v[68:71], v86 offset0:48 offset1:72
    ds_read2_b64 v[80:83], v87 offset0:0 offset1:24
    ds_read2_b64 v[84:87], v87 offset0:48 offset1:72
    s_waitcnt lgkmcnt(4)
    v_pk_add_f32 v[72:73], v[72:73], v[74:75]
    v_pk_add_f32 v[76:77], v[76:77], v[78:79]
    v_pk_add_f32 v[72:73], v[72:73], v[76:77]
    v_mul_f32 v74, 0x3b000000, v73
    v_mul_f32 v72, 0x3b000000, v72
    v_fma_f32 v72, -v74, v74, v72
    v_max_f32 v72, 0, v72
    v_add_f32 v72, 0x3727c5ac, v72
    v_rsq_f32 v76, v72
    s_waitcnt lgkmcnt(0)
    v_pk_add_f32 v[64:65], v[64:65], v[66:67]
    v_pk_add_f32 v[68:69], v[68:69], v[70:71]
    v_pk_add_f32 v[80:81], v[80:81], v[82:83]
    v_pk_add_f32 v[84:85], v[84:85], v[86:87]
    v_pk_add_f32 v[64:65], v[64:65], v[68:69]
    v_pk_add_f32 v[80:81], v[80:81], v[84:85]
    v_pk_fma_f32 v[64:65], v[80:81], v[74:75], v[64:65] op_sel_hi:[1,0,1] neg_lo:[1,0,0] neg_hi:[1,0,0]
    v_pk_mul_f32 v[64:65], v[64:65], v[76:77] op_sel_hi:[1,0]
    v_pk_add_f32 v[64:65], v[64:65], v[92:93]
    v_pk_mul_f32 v[66:67], v[64:65], v[64:65]
    v_pk_fma_f32 v[66:67], v[66:67], v[94:95], v[96:97] op_sel_hi:[1,0,0]
    v_pk_mul_f32 v[66:67], v[66:67], v[64:65]
    v_exp_f32 v66, v66
    v_exp_f32 v67, v67
    v_add_f32 v66, 1.0, v66
    v_add_f32 v67, 1.0, v67
    v_rcp_f32 v66, v66
    v_rcp_f32 v67, v67
    s_cmp_eq_u32 s69, 0
    v_pk_mul_f32 v[64:65], v[64:65], v[66:67]
    v_cvt_pk_bf16_f32 v64, v64, v65
    v_min_u32 v64, -2, v64
    v_and_b32 v64, s95, v64
    s_cbranch_scc1 L_slow_24
    buffer_store_dword v64, v98, s[16:19], s86 offen
L_back_25:
    s_mov_b64 exec, -1
L_S5:
    s_cmp_lg_u32 s3, 0
    s_cbranch_scc1 L_S7
    ds_read_b64_tr_b16 v[16:17], v10 offset:49152
    ds_read_b64_tr_b16 v[18:19], v10 offset:49280
    ds_read_b64_tr_b16 v[20:21], v10 offset:50176
    ds_read_b64_tr_b16 v[22:23], v10 offset:50304
    ds_read_b64_tr_b16 v[24:25], v10 offset:51200
    ds_read_b64_tr_b16 v[26:27], v10 offset:51328
    ds_read_b64_tr_b16 v[28:29], v10 offset:52224
    ds_read_b64_tr_b16 v[30:31], v10 offset:52352
    ds_read_b64_tr_b16 v[32:33], v10 offset:53248
    ds_read_b64_tr_b16 v[34:35], v10 offset:53376
    ds_read_b64_tr_b16 v[36:37], v10 offset:54272
    ds_read_b64_tr_b16 v[38:39], v10 offset:54400
    v_mov_b32 v60, 0
    v_mov_b32 v61, 0
    v_mov_b32 v62, 0
    v_mov_b32 v63, 0
    v_and_b32 v86, 1, v0
    v_lshrrev_b32 v87, 4, v0
    v_lshlrev_b32 v87, 4, v87
    v_lshl_add_u32 v85, v86, 6, v87
    v_lshlrev_b32 v87, 1, v87
    v_lshl_add_u32 v84, v86, 4, v87
    v_mov_b32 v86, 56896
    ds_read_b64 v[98:99], v86
    s_mov_b64 exec, s[58:59]
    buffer_load_dwordx4 v[60:63], v84, s[16:19], s87 offen offset:640 sc1
    s_mov_b64 exec, s[56:57]
    buffer_load_dwordx4 v[40:43], v84, s[16:19], s87 offen offset:0 sc1
    buffer_load_dwordx4 v[44:47], v84, s[16:19], s87 offen offset:128 sc1
    buffer_load_dwordx4 v[48:51], v84, s[16:19], s87 offen offset:256 sc1
    buffer_load_dwordx4 v[52:55], v84, s[16:19], s87 offen offset:384 sc1
    buffer_load_dwordx4 v[56:59], v84, s[16:19], s87 offen offset:512 sc1
    s_sleep 1
L_poll_26:
    s_mov_b64 exec, s[58:59]
    buffer_load_dwordx4 v[60:63], v84, s[16:19], s87 offen offset:640 sc1
    s_mov_b64 exec, s[56:57]
    buffer_load_dwordx4 v[40:43], v84, s[16:19], s87 offen offset:0 sc1
    buffer_load_dwordx4 v[44:47], v84, s[16:19], s87 offen offset:128 sc1
    buffer_load_dwordx4 v[48:51], v84, s[16:19], s87 offen offset:256 sc1
    buffer_load_dwordx4 v[52:55], v84, s[16:19], s87 offen offset:384 sc1
    buffer_load_dwordx4 v[56:59], v84, s[16:19], s87 offen offset:512 sc1
    s_add_u32 s68, s68, 1
    s_cmp_lt_u32 s68, 100000
    s_cselect_b64 s[64:65], -1, 0
    s_waitcnt vmcnt(6)
    v_max_u32 v88, v40, v41
    v_max3_u32 v88, v88, v42, v43
    v_max3_u32 v88, v88, v44, v45
    v_max3_u32 v88, v88, v46, v47
    v_max3_u32 v88, v88, v48, v49
    v_max3_u32 v88, v88, v50, v51
    v_max3_u32 v88, v88, v52, v53
    v_max3_u32 v88, v88, v54, v55
    v_max3_u32 v88, v88, v56, v57
    v_max3_u32 v88, v88, v58, v59
    v_max3_u32 v88, v88, v60, v61
    v_max3_u32 v88, v88, v62, v63
    v_cmp_eq_u32 vcc, -1, v88
    s_and_b64 vcc, vcc, s[64:65]
    s_cbranch_scc1 L_poll_26
    s_mov_b64 exec, -1
    s_waitcnt lgkmcnt(0)
    v_mfma_f32_16x16x32_bf16 v[90:93], v[16:19], v[40:43], 0
    v_mfma_f32_16x16x32_bf16 v[94:97], v[20:23], v[44:47], 0
    v_mfma_f32_16x16x32_bf16 v[90:93], v[24:27], v[48:51], v[90:93]
    v_mfma_f32_16x16x32_bf16 v[94:97], v[28:31], v[52:55], v[94:97]
    v_mfma_f32_16x16x32_bf16 v[90:93], v[32:35], v[56:59], v[90:93]
    v_mfma_f32_16x16x32_bf16 v[94:97], v[36:39], v[60:63], v[94:97]
    s_add_u32 s75, s88, 8192
    s_mov_b64 exec, s[56:57]
    s_waitcnt vmcnt(0)
    s_nop 4
    v_pk_add_f32 v[90:91], v[90:91], v[94:95]
    v_pk_add_f32 v[92:93], v[92:93], v[96:97]
    v_min_u32 v90, -2, v90
    v_min_u32 v91, -2, v91
    v_min_u32 v92, -2, v92
    v_min_u32 v93, -2, v93
    buffer_store_dwordx4 v[90:93], v85, s[16:19], s88 offen sc1
    buffer_store_dwordx4 v[90:93], v85, s[16:19], s75 offen sc1
    s_mov_b64 exec, -1
    s_cmp_eq_u32 s70, 0
    s_cselect_b32 s75, 0, s4
    s_cmp_lg_u32 s75, 0
    s_cbranch_scc1 L_done
    v_readfirstlane_b32 s77, v98
    v_readfirstlane_b32 s76, v99
    s_nop 0
    s_cmp_lt_u32 s76, s77
    s_cselect_b32 s94, 8192, 0
    ds_read_b64_tr_b16 v[16:17], v8 offset:0
    ds_read_b64_tr_b16 v[18:19], v8 offset:128
    ds_read_b64_tr_b16 v[20:21], v8 offset:256
    ds_read_b64_tr_b16 v[22:23], v8 offset:384
    ds_read_b64_tr_b16 v[24:25], v8 offset:512
    ds_read_b64_tr_b16 v[26:27], v8 offset:640
    ds_read_b64_tr_b16 v[28:29], v8 offset:768
    ds_read_b64_tr_b16 v[30:31], v8 offset:896
    v_bfe_u32 v84, v0, 2, 2
    v_cmp_eq_u32 vcc, 2, v84
    v_mov_b32 v85, 0x3f803f80
    s_mul_i32 s75, s3, 192
    s_add_u32 s75, s75, 55808
    v_cndmask_b32 v32, 0, v85, vcc
    v_mov_b32 v33, v32
    v_mov_b32 v34, v32
    v_mov_b32 v35, v32
    s_mov_b64 exec, s[0:1]
    buffer_load_dwordx4 v[32:35], v9, s[16:19], s91 offen sc1
    s_mov_b64 exec, -1
    v_lshlrev_b32 v84, 2, v0
    v_add_u32 v84, s75, v84
    s_lshl_b32 s75, s3, 4
    s_add_u32 s75, s75, 56576
    v_bfe_u32 v85, v0, 2, 1
    v_lshrrev_b32 v86, 5, v0
    v_lshlrev_b32 v85, 3, v85
    v_lshl_add_u32 v85, v86, 2, v85
    v_add_u32 v85, s75, v85
    v_lshlrev_b32 v86, 3, v0
    v_and_b32 v87, 56, v86
    v_add_u32 v86, 55808, v86
    v_add_u32 v87, 55936, v87
    v_and_b32 v88, 8, v0
    v_add_u32 v88, 56576, v88
    s_mov_b64 exec, s[60:61]
    v_lshlrev_b32 v82, 3, v0
    v_lshlrev_b32 v80, 16, v13
    v_and_b32 v81, 0xffff0000, v13
    v_lshlrev_b32 v90, 16, v15
    v_and_b32 v91, 0xffff0000, v15
    v_pk_add_f32 v[80:81], v[80:81], v[90:91]
    v_lshlrev_b32 v83, 2, v0
    v_and_b32 v83, 28, v83
    v_bfe_u32 v89, v0, 3, 1
    v_lshl_add_u32 v83, v89, 10, v83
    s_add_u32 s75, s89, s94
    s_sleep 4
    buffer_load_dwordx2 v[64:65], v82, s[16:19], s75 offen offset:0 sc1
    buffer_load_dwordx2 v[66:67], v82, s[16:19], s75 offen offset:128 sc1
    buffer_load_dwordx2 v[68:69], v82, s[16:19], s75 offen offset:256 sc1
    buffer_load_dwordx2 v[70:71], v82, s[16:19], s75 offen offset:384 sc1
    buffer_load_dwordx2 v[72:73], v82, s[16:19], s75 offen offset:512 sc1
    buffer_load_dwordx2 v[74:75], v82, s[16:19], s75 offen offset:640 sc1
    buffer_load_dwordx2 v[76:77], v82, s[16:19], s75 offen offset:768 sc1
    buffer_load_dwordx2 v[78:79], v82, s[16:19], s75 offen offset:896 sc1
    s_sleep 2
    buffer_load_dwordx2 v[64:65], v82, s[16:19], s75 offen offset:0 sc1
    buffer_load_dwordx2 v[66:67], v82, s[16:19], s75 offen offset:128 sc1
    buffer_load_dwordx2 v[68:69], v82, s[16:19], s75 offen offset:256 sc1
    buffer_load_dwordx2 v[70:71], v82, s[16:19], s75 offen offset:384 sc1
    buffer_load_dwordx2 v[72:73], v82, s[16:19], s75 offen offset:512 sc1
    buffer_load_dwordx2 v[74:75], v82, s[16:19], s75 offen offset:640 sc1
    buffer_load_dwordx2 v[76:77], v82, s[16:19], s75 offen offset:768 sc1
    buffer_load_dwordx2 v[78:79], v82, s[16:19], s75 offen offset:896 sc1
    s_sleep 2
L_poll_27:
    buffer_load_dwordx2 v[64:65], v82, s[16:19], s75 offen offset:0 sc1
    buffer_load_dwordx2 v[66:67], v82, s[16:19], s75 offen offset:128 sc1
    buffer_load_dwordx2 v[68:69], v82, s[16:19], s75 offen offset:256 sc1
    buffer_load_dwordx2 v[70:71], v82, s[16:19], s75 offen offset:384 sc1
    buffer_load_dwordx2 v[72:73], v82, s[16:19], s75 offen offset:512 sc1
    buffer_load_dwordx2 v[74:75], v82, s[16:19], s75 offen offset:640 sc1
    buffer_load_dwordx2 v[76:77], v82, s[16:19], s75 offen offset:768 sc1
    buffer_load_dwordx2 v[78:79], v82, s[16:19], s75 offen offset:896 sc1
    s_add_u32 s68, s68, 1
    s_waitcnt vmcnt(16)
    v_pk_add_f32 v[90:91], v[64:65], v[66:67]
    v_pk_add_f32 v[92:93], v[68:69], v[70:71]
    v_pk_add_f32 v[94:95], v[72:73], v[74:75]
    v_pk_add_f32 v[96:97], v[76:77], v[78:79]
    v_pk_add_f32 v[90:91], v[90:91], v[92:93]
    v_pk_add_f32 v[94:95], v[94:95], v[96:97]
    v_pk_add_f32 v[90:91], v[90:91], v[80:81]
    v_pk_add_f32 v[90:91], v[90:91], v[94:95]
    s_cmp_eq_u32 s69, 0
    v_cmp_u_f32 vcc, v90, v91
    s_cbranch_vccnz L_exact_29
L_ok_28:
    v_cvt_pk_bf16_f32 v13, v90, v91
    s_cmp_lg_u32 s70, 0
    s_cbranch_scc1 L_fin
    v_min_u32 v90, -2, v13
    s_cmp_eq_u32 s69, 0
    s_cbranch_scc1 L_slow_30
    buffer_store_dword v90, v83, s[16:19], s90 offen
L_back_31:
    s_mov_b64 exec, -1
    s_branch L_S7b
L_S7:
    s_cmp_lg_u32 s70, 0
    s_cbranch_scc1 L_done
    s_waitcnt vmcnt(0)
    ds_read_b64_tr_b16 v[16:17], v8 offset:0
    ds_read_b64_tr_b16 v[18:19], v8 offset:128
    ds_read_b64_tr_b16 v[20:21], v8 offset:256
    ds_read_b64_tr_b16 v[22:23], v8 offset:384
    ds_read_b64_tr_b16 v[24:25], v8 offset:512
    ds_read_b64_tr_b16 v[26:27], v8 offset:640
    ds_read_b64_tr_b16 v[28:29], v8 offset:768
    ds_read_b64_tr_b16 v[30:31], v8 offset:896
    v_bfe_u32 v84, v0, 2, 2
    v_cmp_eq_u32 vcc, 2, v84
    v_mov_b32 v85, 0x3f803f80
    s_mul_i32 s75, s3, 192
    s_add_u32 s75, s75, 55808
    v_cndmask_b32 v32, 0, v85, vcc
    v_mov_b32 v33, v32
    v_mov_b32 v34, v32
    v_mov_b32 v35, v32
    s_mov_b64 exec, s[0:1]
    buffer_load_dwordx4 v[32:35], v9, s[16:19], s91 offen sc1
    s_mov_b64 exec, -1
    v_lshlrev_b32 v84, 2, v0
    v_add_u32 v84, s75, v84
    s_lshl_b32 s75, s3, 4
    s_add_u32 s75, s75, 56576
    v_bfe_u32 v85, v0, 2, 1
    v_lshrrev_b32 v86, 5, v0
    v_lshlrev_b32 v85, 3, v85
    v_lshl_add_u32 v85, v86, 2, v85
    v_add_u32 v85, s75, v85
    v_lshlrev_b32 v86, 3, v0
    v_and_b32 v87, 56, v86
    v_add_u32 v86, 55808, v86
    v_add_u32 v87, 55936, v87
    v_and_b32 v88, 8, v0
    v_add_u32 v88, 56576, v88
L_S7b:
    s_barrier
    s_mov_b64 exec, s[0:1]
    buffer_load_dwordx4 v[32:35], v9, s[16:19], s91 offen sc1
    s_sleep 1
L_poll_32:
    buffer_load_dwordx4 v[32:35], v9, s[16:19], s91 offen sc1
    s_add_u32 s68, s68, 1
    s_cmp_lt_u32 s68, 100000
    s_cselect_b64 s[64:65], -1, 0
    s_waitcnt vmcnt(1)
    v_max_u32 v63, v32, v33
    v_max3_u32 v63, v63, v34, v35
    v_cmp_eq_u32 vcc, -1, v63
    s_and_b64 vcc, vcc, s[64:65]
    s_cbranch_scc1 L_poll_32
    s_mov_b64 exec, -1
    s_waitcnt lgkmcnt(0)
    v_mfma_f32_16x16x32_bf16 v[52:55], v[32:35], v[32:35], 0
    v_mfma_f32_16x16x32_bf16 v[36:39], v[32:35], v[16:19], 0
    v_mfma_f32_16x16x32_bf16 v[40:43], v[32:35], v[20:23], 0
    v_mfma_f32_16x16x32_bf16 v[44:47], v[32:35], v[24:27], 0
    v_mfma_f32_16x16x32_bf16 v[48:51], v[32:35], v[28:31], 0
    s_nop 3
    v_mov_b32_dpp v56, v52 quad_perm:[0,0,0,0] row_mask:0xf bank_mask:0xf
    v_add_f32_dpp v56, v53, v56 quad_perm:[1,1,1,1] row_mask:0xf bank_mask:0xf
    v_add_f32_dpp v56, v54, v56 quad_perm:[2,2,2,2] row_mask:0xf bank_mask:0xf
    v_add_f32_dpp v56, v55, v56 quad_perm:[3,3,3,3] row_mask:0xf bank_mask:0xf
    s_mov_b32 exec_lo, 0x00100001
    s_mov_b32 exec_hi, 0x11
    ds_write_b32 v85, v56
    s_mov_b32 exec_lo, -1
    s_mov_b32 exec_hi, 0xffff
    v_add_f32 v36, v36, v41
    v_add_f32 v46, v46, v51
    v_add_f32 v36, v36, v46
    ds_write_b32 v84, v36
    s_mov_b64 exec, -1
    s_waitcnt lgkmcnt(0)
    s_barrier
    s_cmp_lg_u32 s3, 0
    s_cbranch_scc1 L_S8
    s_mov_b64 exec, s[60:61]
    s_waitcnt vmcnt(0)
    v_lshlrev_b32 v98, 2, v0
    v_and_b32 v98, 28, v98
    v_bfe_u32 v99, v0, 3, 1
    v_lshl_add_u32 v98, v99, 8, v98
    ds_read2_b64 v[72:75], v88 offset0:0 offset1:2
    ds_read2_b64 v[76:79], v88 offset0:4 offset1:6
    ds_read2_b64 v[64:67], v86 offset0:0 offset1:24
    ds_read2_b64 v[68:71], v86 offset0:48 offset1:72
    ds_read2_b64 v[80:83], v87 offset0:0 offset1:24
    ds_read2_b64 v[84:87], v87 offset0:48 offset1:72
    s_waitcnt lgkmcnt(4)
    v_pk_add_f32 v[72:73], v[72:73], v[74:75]
    v_pk_add_f32 v[76:77], v[76:77], v[78:79]
    v_pk_add_f32 v[72:73], v[72:73], v[76:77]
    v_mul_f32 v74, 0x3b000000, v73
    v_mul_f32 v72, 0x3b000000, v72
    v_fma_f32 v72, -v74, v74, v72
    v_max_f32 v72, 0, v72
    v_add_f32 v72, 0x3727c5ac, v72
    v_rsq_f32 v76, v72
    s_waitcnt lgkmcnt(0)
    v_pk_add_f32 v[64:65], v[64:65], v[66:67]
    v_pk_add_f32 v[68:69], v[68:69], v[70:71]
    v_pk_add_f32 v[80:81], v[80:81], v[82:83]
    v_pk_add_f32 v[84:85], v[84:85], v[86:87]
    v_pk_add_f32 v[64:65], v[64:65], v[68:69]
    v_pk_add_f32 v[80:81], v[80:81], v[84:85]
    v_pk_fma_f32 v[64:65], v[80:81], v[74:75], v[64:65] op_sel_hi:[1,0,1] neg_lo:[1,0,0] neg_hi:[1,0,0]
    v_pk_mul_f32 v[64:65], v[64:65], v[76:77] op_sel_hi:[1,0]
    s_cmp_eq_u32 s69, 0
    v_cvt_pk_bf16_f32 v64, v64, v65
    v_min_u32 v64, -2, v64
    s_cbranch_scc1 L_slow_33
    buffer_store_dword v64, v98, s[16:19], s92 offen
L_back_34:
    s_mov_b64 exec, -1
L_S8:
    ds_read_b128 v[64:67], v1 offset:0
    ds_read_b128 v[68:71], v1 offset:1024
    ds_read_b128 v[72:75], v1 offset:2048
    ds_read_b128 v[76:79], v1 offset:3072
    ds_read_b128 v[80:83], v1 offset:4096
    ds_read_b128 v[84:87], v1 offset:5120
    ds_read_b128 v[88:91], v1 offset:6144
    ds_read_b128 v[92:95], v1 offset:7168
    v_mov_b32 v16, 0
    v_mov_b32 v17, 0
    v_mov_b32 v18, 0
    v_mov_b32 v19, 0
    v_mov_b32 v20, 0
    v_mov_b32 v21, 0
    v_mov_b32 v22, 0
    v_mov_b32 v23, 0
    v_mov_b32 v24, 0
    v_mov_b32 v25, 0
    v_mov_b32 v26, 0
    v_mov_b32 v27, 0
    v_mov_b32 v28, 0
    v_mov_b32 v29, 0
    v_mov_b32 v30, 0
    v_mov_b32 v31, 0
    v_mov_b32 v63, 0x3e0293ee
    v_and_b32 v62, 0xf0, v6
    s_mov_b32 s70, 1
    buffer_load_dwordx4 v[96:99], v62, s[16:19], s93 offen sc1
    s_sleep 1
L_poll_35:
    buffer_load_dwordx4 v[96:99], v62, s[16:19], s93 offen sc1
    s_add_u32 s68, s68, 1
    s_cmp_lt_u32 s68, 100000
    s_cselect_b64 s[64:65], -1, 0
    s_waitcnt vmcnt(1)
    v_max_u32 v61, v96, v97
    v_max3_u32 v61, v61, v98, v99
    v_cmp_eq_u32 vcc, -1, v61
    s_and_b64 vcc, vcc, s[64:65]
    s_cbranch_scc1 L_poll_35
    s_add_u32 s16, s16, 262144
    s_addc_u32 s17, s17, 0
    s_sub_u32 s18, s18, 262144
L_att2:
    v_mov_b32_dpp v16, v96 quad_perm:[0,1,2,3] row_mask:0xf bank_mask:0x1
    v_mov_b32_dpp v17, v97 quad_perm:[0,1,2,3] row_mask:0xf bank_mask:0x1
    v_mov_b32_dpp v18, v98 quad_perm:[0,1,2,3] row_mask:0xf bank_mask:0x1
    v_mov_b32_dpp v19, v99 quad_perm:[0,1,2,3] row_mask:0xf bank_mask:0x1
    v_mov_b32_dpp v20, v96 quad_perm:[0,1,2,3] row_mask:0xf bank_mask:0x2
    v_mov_b32_dpp v21, v97 quad_perm:[0,1,2,3] row_mask:0xf bank_mask:0x2
    v_mov_b32_dpp v22, v98 quad_perm:[0,1,2,3] row_mask:0xf bank_mask:0x2
    v_mov_b32_dpp v23, v99 quad_perm:[0,1,2,3] row_mask:0xf bank_mask:0x2
    s_waitcnt lgkmcnt(0)
    v_mfma_f32_16x16x32_bf16 v[48:51], v[16:19], v[64:67], 0
    v_mov_b32_dpp v24, v96 quad_perm:[0,1,2,3] row_mask:0xf bank_mask:0x4
    v_mov_b32_dpp v25, v97 quad_perm:[0,1,2,3] row_mask:0xf bank_mask:0x4
    v_mov_b32_dpp v26, v98 quad_perm:[0,1,2,3] row_mask:0xf bank_mask:0x4
    v_mov_b32_dpp v27, v99 quad_perm:[0,1,2,3] row_mask:0xf bank_mask:0x4
    v_mfma_f32_16x16x32_bf16 v[48:51], v[20:23], v[68:71], v[48:51]
    v_mov_b32_dpp v28, v96 quad_perm:[0,1,2,3] row_mask:0xf bank_mask:0x8
    v_mov_b32_dpp v29, v97 quad_perm:[0,1,2,3] row_mask:0xf bank_mask:0x8
    v_mov_b32_dpp v30, v98 quad_perm:[0,1,2,3] row_mask:0xf bank_mask:0x8
    v_mov_b32_dpp v31, v99 quad_perm:[0,1,2,3] row_mask:0xf bank_mask:0x8
    v_mfma_f32_16x16x32_bf16 v[48:51], v[24:27], v[72:75], v[48:51]
    s_nop 0
    v_mfma_f32_16x16x32_bf16 v[48:51], v[28:31], v[76:79], v[48:51]
    v_mfma_f32_16x16x32_bf16 v[52:55], v[16:19], v[80:83], 0
    ds_read_b128 v[64:67], v1 offset:8192
    v_mfma_f32_16x16x32_bf16 v[52:55], v[20:23], v[84:87], v[52:55]
    ds_read_b128 v[68:71], v1 offset:9216
    v_mfma_f32_16x16x32_bf16 v[52:55], v[24:27], v[88:91], v[52:55]
    ds_read_b128 v[72:75], v1 offset:10240
    v_mfma_f32_16x16x32_bf16 v[52:55], v[28:31], v[92:95], v[52:55]
    ds_read_b128 v[76:79], v1 offset:11264
    v_mfma_f32_16x16x32_bf16 v[56:59], v[16:19], a[0:3], 0
    v_mul_f32_dpp v32, v48, v63 quad_perm:[0,0,0,0] row_mask:0xf bank_mask:0xf
    ds_read_b128 v[80:83], v1 offset:12288
    v_mfma_f32_16x16x32_bf16 v[56:59], v[20:23], a[4:7], v[56:59]
    v_fmac_f32_dpp v32, v49, v63 quad_perm:[1,1,1,1] row_mask:0xf bank_mask:0xf
    v_mfma_f32_16x16x32_bf16 v[56:59], v[24:27], a[8:11], v[56:59]
    v_fmac_f32_dpp v32, v50, v63 quad_perm:[2,2,2,2] row_mask:0xf bank_mask:0xf
    v_mfma_f32_16x16x32_bf16 v[56:59], v[28:31], a[12:15], v[56:59]
    v_fmac_f32_dpp v32, v51, v63 quad_perm:[3,3,3,3] row_mask:0xf bank_mask:0xf
    v_mfma_f32_16x16x32_bf16 v[48:51], v[16:19], a[16:19], 0
    v_mul_f32_dpp v33, v52, v63 quad_perm:[0,0,0,0] row_mask:0xf bank_mask:0xf
    ds_read_b128 v[84:87], v1 offset:13312
    v_mfma_f32_16x16x32_bf16 v[48:51], v[20:23], a[20:23], v[48:51]
    v_fmac_f32_dpp v33, v53, v63 quad_perm:[1,1,1,1] row_mask:0xf bank_mask:0xf
    v_mfma_f32_16x16x32_bf16 v[48:51], v[24:27], a[24:27], v[48:51]
    v_fmac_f32_dpp v33, v54, v63 quad_perm:[2,2,2,2] row_mask:0xf bank_mask:0xf
    v_mfma_f32_16x16x32_bf16 v[48:51], v[28:31], a[28:31], v[48:51]
    v_fmac_f32_dpp v33, v55, v63 quad_perm:[3,3,3,3] row_mask:0xf bank_mask:0xf
    v_mfma_f32_16x16x32_bf16 v[52:55], v[16:19], a[32:35], 0
    v_mul_f32_dpp v35, v56, v63 quad_perm:[0,0,0,0] row_mask:0xf bank_mask:0xf
    ds_read_b128 v[88:91], v1 offset:14336
    v_mfma_f32_16x16x32_bf16 v[52:55], v[20:23], a[36:39], v[52:55]
    v_fmac_f32_dpp v35, v57, v63 quad_perm:[1,1,1,1] row_mask:0xf bank_mask:0xf
    v_max_f32 v60, v32, v33
    v_mfma_f32_16x16x32_bf16 v[52:55], v[24:27], a[40:43], v[52:55]
    v_fmac_f32_dpp v35, v58, v63 quad_perm:[2,2,2,2] row_mask:0xf bank_mask:0xf
    v_mfma_f32_16x16x32_bf16 v[52:55], v[28:31], a[44:47], v[52:55]
    v_fmac_f32_dpp v35, v59, v63 quad_perm:[3,3,3,3] row_mask:0xf bank_mask:0xf
    s_waitcnt lgkmcnt(3)
    v_mfma_f32_16x16x32_bf16 v[56:59], v[16:19], v[64:67], 0
    v_mul_f32_dpp v36, v48, v63 quad_perm:[0,0,0,0] row_mask:0xf bank_mask:0xf
    ds_read_b128 v[92:95], v1 offset:15360
    v_mfma_f32_16x16x32_bf16 v[56:59], v[20:23], v[68:71], v[56:59]
    v_fmac_f32_dpp v36, v49, v63 quad_perm:[1,1,1,1] row_mask:0xf bank_mask:0xf
    v_mfma_f32_16x16x32_bf16 v[56:59], v[24:27], v[72:75], v[56:59]
    v_fmac_f32_dpp v36, v50, v63 quad_perm:[2,2,2,2] row_mask:0xf bank_mask:0xf
    v_mfma_f32_16x16x32_bf16 v[56:59], v[28:31], v[76:79], v[56:59]
    v_fmac_f32_dpp v36, v51, v63 quad_perm:[3,3,3,3] row_mask:0xf bank_mask:0xf
    v_mfma_f32_16x16x32_bf16 v[48:51], v[16:19], a[48:51], 0
    v_mul_f32_dpp v37, v52, v63 quad_perm:[0,0,0,0] row_mask:0xf bank_mask:0xf
    ds_read_b128 v[64:67], v1 offset:16384
    v_mfma_f32_16x16x32_bf16 v[48:51], v[20:23], a[52:55], v[48:51]
    v_fmac_f32_dpp v37, v53, v63 quad_perm:[1,1,1,1] row_mask:0xf bank_mask:0xf
    v_max3_f32 v60, v60, v35, v36
    v_mfma_f32_16x16x32_bf16 v[48:51], v[24:27], a[56:59], v[48:51]
    v_fmac_f32_dpp v37, v54, v63 quad_perm:[2,2,2,2] row_mask:0xf bank_mask:0xf
    v_mfma_f32_16x16x32_bf16 v[48:51], v[28:31], a[60:63], v[48:51]
    v_fmac_f32_dpp v37, v55, v63 quad_perm:[3,3,3,3] row_mask:0xf bank_mask:0xf
    v_mfma_f32_16x16x32_bf16 v[52:55], v[16:19], a[64:67], 0
    v_mul_f32_dpp v34, v56, v63 quad_perm:[0,0,0,0] row_mask:0xf bank_mask:0xf
    ds_read_b128 v[68:71], v1 offset:17408
    v_mfma_f32_16x16x32_bf16 v[52:55], v[20:23], a[68:71], v[52:55]
    v_fmac_f32_dpp v34, v57, v63 quad_perm:[1,1,1,1] row_mask:0xf bank_mask:0xf
    v_mfma_f32_16x16x32_bf16 v[52:55], v[24:27], a[72:75], v[52:55]
    v_fmac_f32_dpp v34, v58, v63 quad_perm:[2,2,2,2] row_mask:0xf bank_mask:0xf
    v_mfma_f32_16x16x32_bf16 v[52:55], v[28:31], a[76:79], v[52:55]
    v_fmac_f32_dpp v34, v59, v63 quad_perm:[3,3,3,3] row_mask:0xf bank_mask:0xf
    v_mfma_f32_16x16x32_bf16 v[56:59], v[16:19], a[80:83], 0
    v_mul_f32_dpp v38, v48, v63 quad_perm:[0,0,0,0] row_mask:0xf bank_mask:0xf
    ds_read_b128 v[72:75], v1 offset:18432
    v_mfma_f32_16x16x32_bf16 v[56:59], v[20:23], a[84:87], v[56:59]
    v_fmac_f32_dpp v38, v49, v63 quad_perm:[1,1,1,1] row_mask:0xf bank_mask:0xf
    v_max3_f32 v60, v60, v37, v34
    v_mfma_f32_16x16x32_bf16 v[56:59], v[24:27], a[88:91], v[56:59]
    v_fmac_f32_dpp v38, v50, v63 quad_perm:[2,2,2,2] row_mask:0xf bank_mask:0xf
    v_mfma_f32_16x16x32_bf16 v[56:59], v[28:31], a[92:95], v[56:59]
    v_fmac_f32_dpp v38, v51, v63 quad_perm:[3,3,3,3] row_mask:0xf bank_mask:0xf
    v_mfma_f32_16x16x32_bf16 v[48:51], v[16:19], a[96:99], 0
    v_mul_f32_dpp v39, v52, v63 quad_perm:[0,0,0,0] row_mask:0xf bank_mask:0xf
    ds_read_b128 v[76:79], v1 offset:19456
    v_mfma_f32_16x16x32_bf16 v[48:51], v[20:23], a[100:103], v[48:51]
    v_fmac_f32_dpp v39, v53, v63 quad_perm:[1,1,1,1] row_mask:0xf bank_mask:0xf
    v_mfma_f32_16x16x32_bf16 v[48:51], v[24:27], a[104:107], v[48:51]
    v_fmac_f32_dpp v39, v54, v63 quad_perm:[2,2,2,2] row_mask:0xf bank_mask:0xf
    v_mfma_f32_16x16x32_bf16 v[48:51], v[28:31], a[108:111], v[48:51]
    v_fmac_f32_dpp v39, v55, v63 quad_perm:[3,3,3,3] row_mask:0xf bank_mask:0xf
    v_mfma_f32_16x16x32_bf16 v[52:55], v[16:19], a[112:115], 0
    v_mul_f32_dpp v40, v56, v63 quad_perm:[0,0,0,0] row_mask:0xf bank_mask:0xf
    v_max3_f32 v60, v60, v38, v39
    v_mfma_f32_16x16x32_bf16 v[52:55], v[20:23], a[116:119], v[52:55]
    v_fmac_f32_dpp v40, v57, v63 quad_perm:[1,1,1,1] row_mask:0xf bank_mask:0xf
    v_mfma_f32_16x16x32_bf16 v[52:55], v[24:27], a[120:123], v[52:55]
    v_fmac_f32_dpp v40, v58, v63 quad_perm:[2,2,2,2] row_mask:0xf bank_mask:0xf
    v_mfma_f32_16x16x32_bf16 v[52:55], v[28:31], a[124:127], v[52:55]
    v_fmac_f32_dpp v40, v59, v63 quad_perm:[3,3,3,3] row_mask:0xf bank_mask:0xf
    v_mfma_f32_16x16x32_bf16 v[56:59], v[16:19], a[128:131], 0
    v_mul_f32_dpp v41, v48, v63 quad_perm:[0,0,0,0] row_mask:0xf bank_mask:0xf
    v_mfma_f32_16x16x32_bf16 v[56:59], v[20:23], a[132:135], v[56:59]
    v_fmac_f32_dpp v41, v49, v63 quad_perm:[1,1,1,1] row_mask:0xf bank_mask:0xf
    v_mfma_f32_16x16x32_bf16 v[56:59], v[24:27], a[136:139], v[56:59]
    v_fmac_f32_dpp v41, v50, v63 quad_perm:[2,2,2,2] row_mask:0xf bank_mask:0xf
    v_mfma_f32_16x16x32_bf16 v[56:59], v[28:31], a[140:143], v[56:59]
    v_fmac_f32_dpp v41, v51, v63 quad_perm:[3,3,3,3] row_mask:0xf bank_mask:0xf
    v_mfma_f32_16x16x32_bf16 v[48:51], v[16:19], a[144:147], 0
    v_mul_f32_dpp v42, v52, v63 quad_perm:[0,0,0,0] row_mask:0xf bank_mask:0xf
    v_max3_f32 v60, v60, v40, v41
    v_mfma_f32_16x16x32_bf16 v[48:51], v[20:23], a[148:151], v[48:51]
    v_fmac_f32_dpp v42, v53, v63 quad_perm:[1,1,1,1] row_mask:0xf bank_mask:0xf
    v_mfma_f32_16x16x32_bf16 v[48:51], v[24:27], a[152:155], v[48:51]
    v_fmac_f32_dpp v42, v54, v63 quad_perm:[2,2,2,2] row_mask:0xf bank_mask:0xf
    v_mfma_f32_16x16x32_bf16 v[48:51], v[28:31], a[156:159], v[48:51]
    v_fmac_f32_dpp v42, v55, v63 quad_perm:[3,3,3,3] row_mask:0xf bank_mask:0xf
    v_mfma_f32_16x16x32_bf16 v[52:55], v[16:19], a[160:163], 0
    v_mul_f32_dpp v43, v56, v63 quad_perm:[0,0,0,0] row_mask:0xf bank_mask:0xf
    v_mfma_f32_16x16x32_bf16 v[52:55], v[20:23], a[164:167], v[52:55]
    v_fmac_f32_dpp v43, v57, v63 quad_perm:[1,1,1,1] row_mask:0xf bank_mask:0xf
    v_mfma_f32_16x16x32_bf16 v[52:55], v[24:27], a[168:171], v[52:55]
    v_fmac_f32_dpp v43, v58, v63 quad_perm:[2,2,2,2] row_mask:0xf bank_mask:0xf
    v_mfma_f32_16x16x32_bf16 v[52:55], v[28:31], a[172:175], v[52:55]
    v_fmac_f32_dpp v43, v59, v63 quad_perm:[3,3,3,3] row_mask:0xf bank_mask:0xf
    v_mfma_f32_16x16x32_bf16 v[56:59], v[16:19], a[176:179], 0
    v_mul_f32_dpp v44, v48, v63 quad_perm:[0,0,0,0] row_mask:0xf bank_mask:0xf
    v_max3_f32 v60, v60, v42, v43
    v_mfma_f32_16x16x32_bf16 v[56:59], v[20:23], a[180:183], v[56:59]
    v_fmac_f32_dpp v44, v49, v63 quad_perm:[1,1,1,1] row_mask:0xf bank_mask:0xf
    v_mfma_f32_16x16x32_bf16 v[56:59], v[24:27], a[184:187], v[56:59]
    v_fmac_f32_dpp v44, v50, v63 quad_perm:[2,2,2,2] row_mask:0xf bank_mask:0xf
    v_mfma_f32_16x16x32_bf16 v[56:59], v[28:31], a[188:191], v[56:59]
    v_fmac_f32_dpp v44, v51, v63 quad_perm:[3,3,3,3] row_mask:0xf bank_mask:0xf
    v_mfma_f32_16x16x32_bf16 v[48:51], v[16:19], a[192:195], 0
    v_mul_f32_dpp v45, v52, v63 quad_perm:[0,0,0,0] row_mask:0xf bank_mask:0xf
    v_mfma_f32_16x16x32_bf16 v[48:51], v[20:23], a[196:199], v[48:51]
    v_fmac_f32_dpp v45, v53, v63 quad_perm:[1,1,1,1] row_mask:0xf bank_mask:0xf
    v_mfma_f32_16x16x32_bf16 v[48:51], v[24:27], a[200:203], v[48:51]
    v_fmac_f32_dpp v45, v54, v63 quad_perm:[2,2,2,2] row_mask:0xf bank_mask:0xf
    v_mfma_f32_16x16x32_bf16 v[48:51], v[28:31], a[204:207], v[48:51]
    v_fmac_f32_dpp v45, v55, v63 quad_perm:[3,3,3,3] row_mask:0xf bank_mask:0xf
    v_mul_f32_dpp v46, v56, v63 quad_perm:[0,0,0,0] row_mask:0xf bank_mask:0xf
    v_fmac_f32_dpp v46, v57, v63 quad_perm:[1,1,1,1] row_mask:0xf bank_mask:0xf
    v_fmac_f32_dpp v46, v58, v63 quad_perm:[2,2,2,2] row_mask:0xf bank_mask:0xf
    v_fmac_f32_dpp v46, v59, v63 quad_perm:[3,3,3,3] row_mask:0xf bank_mask:0xf
    v_max3_f32 v60, v60, v44, v45
    v_max_f32 v60, v60, v46
    s_nop 0
    v_mul_f32_dpp v47, v48, v63 quad_perm:[0,0,0,0] row_mask:0xf bank_mask:0xf
    v_fmac_f32_dpp v47, v49, v63 quad_perm:[1,1,1,1] row_mask:0xf bank_mask:0xf
    v_fmac_f32_dpp v47, v50, v63 quad_perm:[2,2,2,2] row_mask:0xf bank_mask:0xf
    v_fmac_f32_dpp v47, v51, v63 quad_perm:[3,3,3,3] row_mask:0xf bank_mask:0xf
    v_max_f32 v60, v60, v47
    v_lshrrev_b32 v56, 5, v0
    v_and_b32 v57, 1, v0
    v_max_f32_dpp v60, v60, v60 row_ror:4 row_mask:0xf bank_mask:0xf
    v_lshlrev_b32 v56, 9, v56
    v_lshl_add_u32 v56, v57, 8, v56
    v_max_f32_dpp v60, v60, v60 row_ror:8 row_mask:0xf bank_mask:0xf
    v_and_b32 v57, 28, v0
    v_lshl_add_u32 v56, v57, 2, v56
    v_max_f32_dpp v60, v60, v60 row_bcast:15 row_mask:0xa bank_mask:0xf
    s_lshl_b32 s76, s3, 10
    s_add_u32 s76, s76, 57344
    v_max_f32_dpp v60, v60, v60 row_bcast:31 row_mask:0xc bank_mask:0xf
    v_add_u32 v56, s76, v56
    v_readlane_b32 s75, v60, 63
    v_and_b32 v57, 48, v0
    v_and_b32 v58, 3, v0
    v_mov_b32 v62, s75
    v_sub_f32 v28, v32, v62
    v_sub_f32 v29, v33, v62
    v_exp_f32 v28, v28
    v_exp_f32 v29, v29
    v_cvt_pk_bf16_f32 v32, v28, v28
    v_mov_b32 v63, v28
    v_cvt_pk_bf16_f32 v33, v29, v29
    v_and_b32_dpp v16, v32, v2 row_ror:14 row_mask:0xf bank_mask:0xf
    v_and_b32_dpp v17, v32, v3 row_ror:2 row_mask:0xf bank_mask:0xf
    v_and_b32_dpp v18, v32, v4 row_ror:6 row_mask:0xf bank_mask:0xf
    v_and_b32_dpp v19, v32, v5 row_ror:10 row_mask:0xf bank_mask:0xf
    v_add_f32 v63, v63, v29
    v_and_b32_dpp v20, v32, v2 row_ror:6 row_mask:0xf bank_mask:0xf
    v_and_b32_dpp v21, v32, v3 row_ror:10 row_mask:0xf bank_mask:0xf
    v_and_b32_dpp v22, v32, v4 row_ror:14 row_mask:0xf bank_mask:0xf
    v_and_b32_dpp v23, v32, v5 row_ror:2 row_mask:0xf bank_mask:0xf
    s_waitcnt lgkmcnt(4)
    v_mfma_f32_16x16x32_bf16 v[48:51], v[80:83], v[16:19], 0
    v_and_b32_dpp v24, v33, v2 row_ror:14 row_mask:0xf bank_mask:0xf
    v_and_b32_dpp v25, v33, v3 row_ror:2 row_mask:0xf bank_mask:0xf
    v_sub_f32 v28, v34, v62
    ds_read_b128 v[80:83], v1 offset:20480
    v_mfma_f32_16x16x32_bf16 v[52:55], v[84:87], v[16:19], 0
    v_and_b32_dpp v26, v33, v4 row_ror:6 row_mask:0xf bank_mask:0xf
    v_and_b32_dpp v27, v33, v5 row_ror:10 row_mask:0xf bank_mask:0xf
    v_exp_f32 v28, v28
    ds_read_b128 v[84:87], v1 offset:21504
    v_mfma_f32_16x16x32_bf16 v[48:51], v[88:91], v[20:23], v[48:51]
    v_and_b32_dpp v16, v33, v2 row_ror:6 row_mask:0xf bank_mask:0xf
    v_and_b32_dpp v17, v33, v3 row_ror:10 row_mask:0xf bank_mask:0xf
    v_cvt_pk_bf16_f32 v34, v28, v28
    ds_read_b128 v[88:91], v1 offset:22528
    v_mfma_f32_16x16x32_bf16 v[52:55], v[92:95], v[20:23], v[52:55]
    v_and_b32_dpp v18, v33, v4 row_ror:14 row_mask:0xf bank_mask:0xf
    v_and_b32_dpp v19, v33, v5 row_ror:2 row_mask:0xf bank_mask:0xf
    v_add_f32 v63, v63, v28
    ds_read_b128 v[92:95], v1 offset:23552
    s_waitcnt lgkmcnt(4)
    v_mfma_f32_16x16x32_bf16 v[48:51], v[64:67], v[24:27], v[48:51]
    v_and_b32_dpp v20, v34, v2 row_ror:14 row_mask:0xf bank_mask:0xf
    v_and_b32_dpp v21, v34, v3 row_ror:2 row_mask:0xf bank_mask:0xf
    v_sub_f32 v29, v35, v62
    ds_read_b128 v[64:67], v1 offset:24576
    v_mfma_f32_16x16x32_bf16 v[52:55], v[68:71], v[24:27], v[52:55]
    v_and_b32_dpp v22, v34, v4 row_ror:6 row_mask:0xf bank_mask:0xf
    v_and_b32_dpp v23, v34, v5 row_ror:10 row_mask:0xf bank_mask:0xf
    v_exp_f32 v29, v29
    v_mfma_f32_16x16x32_bf16 v[48:51], v[72:75], v[16:19], v[48:51]
    v_and_b32_dpp v24, v34, v2 row_ror:6 row_mask:0xf bank_mask:0xf
    v_and_b32_dpp v25, v34, v3 row_ror:10 row_mask:0xf bank_mask:0xf
    v_cvt_pk_bf16_f32 v35, v29, v29
    v_mfma_f32_16x16x32_bf16 v[52:55], v[76:79], v[16:19], v[52:55]
    v_and_b32_dpp v26, v34, v4 row_ror:14 row_mask:0xf bank_mask:0xf
    v_and_b32_dpp v27, v34, v5 row_ror:2 row_mask:0xf bank_mask:0xf
    v_add_f32 v63, v63, v29
    s_waitcnt lgkmcnt(1)
    v_mfma_f32_16x16x32_bf16 v[48:51], v[80:83], v[20:23], v[48:51]
    v_and_b32_dpp v16, v35, v2 row_ror:14 row_mask:0xf bank_mask:0xf
    v_and_b32_dpp v17, v35, v3 row_ror:2 row_mask:0xf bank_mask:0xf
    v_sub_f32 v28, v36, v62
    v_mfma_f32_16x16x32_bf16 v[52:55], v[84:87], v[20:23], v[52:55]
    v_and_b32_dpp v18, v35, v4 row_ror:6 row_mask:0xf bank_mask:0xf
    v_and_b32_dpp v19, v35, v5 row_ror:10 row_mask:0xf bank_mask:0xf
    v_exp_f32 v28, v28
    v_mfma_f32_16x16x32_bf16 v[48:51], v[88:91], v[24:27], v[48:51]
    v_and_b32_dpp v20, v35, v2 row_ror:6 row_mask:0xf bank_mask:0xf
    v_and_b32_dpp v21, v35, v3 row_ror:10 row_mask:0xf bank_mask:0xf
    v_cvt_pk_bf16_f32 v36, v28, v28
    v_mfma_f32_16x16x32_bf16 v[52:55], v[92:95], v[24:27], v[52:55]
    v_and_b32_dpp v22, v35, v4 row_ror:14 row_mask:0xf bank_mask:0xf
    v_and_b32_dpp v23, v35, v5 row_ror:2 row_mask:0xf bank_mask:0xf
    v_add_f32 v63, v63, v28
    s_waitcnt lgkmcnt(0)
    v_mfma_f32_16x16x32_bf16 v[48:51], v[64:67], v[16:19], v[48:51]
    v_and_b32_dpp v24, v36, v2 row_ror:14 row_mask:0xf bank_mask:0xf
    v_and_b32_dpp v25, v36, v3 row_ror:2 row_mask:0xf bank_mask:0xf
    v_sub_f32 v29, v37, v62
    v_mfma_f32_16x16x32_bf16 v[52:55], a[208:211], v[16:19], v[52:55]
    v_and_b32_dpp v26, v36, v4 row_ror:6 row_mask:0xf bank_mask:0xf
    v_and_b32_dpp v27, v36, v5 row_ror:10 row_mask:0xf bank_mask:0xf
    v_exp_f32 v29, v29
    v_mfma_f32_16x16x32_bf16 v[48:51], a[212:215], v[20:23], v[48:51]
    v_and_b32_dpp v16, v36, v2 row_ror:6 row_mask:0xf bank_mask:0xf
    v_and_b32_dpp v17, v36, v3 row_ror:10 row_mask:0xf bank_mask:0xf
    v_cvt_pk_bf16_f32 v37, v29, v29
    v_mfma_f32_16x16x32_bf16 v[52:55], a[216:219], v[20:23], v[52:55]
    v_and_b32_dpp v18, v36, v4 row_ror:14 row_mask:0xf bank_mask:0xf
    v_and_b32_dpp v19, v36, v5 row_ror:2 row_mask:0xf bank_mask:0xf
    v_add_f32 v63, v63, v29
    v_mfma_f32_16x16x32_bf16 v[48:51], a[220:223], v[24:27], v[48:51]
    v_and_b32_dpp v20, v37, v2 row_ror:14 row_mask:0xf bank_mask:0xf
    v_and_b32_dpp v21, v37, v3 row_ror:2 row_mask:0xf bank_mask:0xf
    v_sub_f32 v28, v38, v62
    v_lshl_add_u32 v57, v58, 2, v57
    v_mfma_f32_16x16x32_bf16 v[52:55], a[224:227], v[24:27], v[52:55]
    v_and_b32_dpp v22, v37, v4 row_ror:6 row_mask:0xf bank_mask:0xf
    v_and_b32_dpp v23, v37, v5 row_ror:10 row_mask:0xf bank_mask:0xf
    v_exp_f32 v28, v28
    v_mfma_f32_16x16x32_bf16 v[48:51], a[228:231], v[16:19], v[48:51]
    v_and_b32_dpp v24, v37, v2 row_ror:6 row_mask:0xf bank_mask:0xf
    v_and_b32_dpp v25, v37, v3 row_ror:10 row_mask:0xf bank_mask:0xf
    v_cvt_pk_bf16_f32 v38, v28, v28
    v_mfma_f32_16x16x32_bf16 v[52:55], a[232:235], v[16:19], v[52:55]
    v_and_b32_dpp v26, v37, v4 row_ror:14 row_mask:0xf bank_mask:0xf
    v_and_b32_dpp v27, v37, v5 row_ror:2 row_mask:0xf bank_mask:0xf
    v_add_f32 v63, v63, v28
    v_mfma_f32_16x16x32_bf16 v[48:51], a[236:239], v[20:23], v[48:51]
    v_and_b32_dpp v16, v38, v2 row_ror:14 row_mask:0xf bank_mask:0xf
    v_and_b32_dpp v17, v38, v3 row_ror:2 row_mask:0xf bank_mask:0xf
    v_sub_f32 v29, v39, v62
    v_bfe_u32 v58, v0, 2, 2
    v_mfma_f32_16x16x32_bf16 v[52:55], a[240:243], v[20:23], v[52:55]
    v_and_b32_dpp v18, v38, v4 row_ror:6 row_mask:0xf bank_mask:0xf
    v_and_b32_dpp v19, v38, v5 row_ror:10 row_mask:0xf bank_mask:0xf
    v_exp_f32 v29, v29
    v_mfma_f32_16x16x32_bf16 v[48:51], a[244:247], v[24:27], v[48:51]
    v_and_b32_dpp v20, v38, v2 row_ror:6 row_mask:0xf bank_mask:0xf
    v_and_b32_dpp v21, v38, v3 row_ror:10 row_mask:0xf bank_mask:0xf
    v_cvt_pk_bf16_f32 v39, v29, v29
    v_mfma_f32_16x16x32_bf16 v[52:55], a[248:251], v[24:27], v[52:55]
    v_and_b32_dpp v22, v38, v4 row_ror:14 row_mask:0xf bank_mask:0xf
    v_and_b32_dpp v23, v38, v5 row_ror:2 row_mask:0xf bank_mask:0xf
    v_add_f32 v63, v63, v29
    v_mfma_f32_16x16x32_bf16 v[48:51], a[252:255], v[16:19], v[48:51]
    v_and_b32_dpp v24, v39, v2 row_ror:14 row_mask:0xf bank_mask:0xf
    v_and_b32_dpp v25, v39, v3 row_ror:2 row_mask:0xf bank_mask:0xf
    v_sub_f32 v28, v40, v62
    v_add_u32 v57, v57, v58
    v_mfma_f32_16x16x32_bf16 v[52:55], v[100:103], v[16:19], v[52:55]
    v_and_b32_dpp v26, v39, v4 row_ror:6 row_mask:0xf bank_mask:0xf
    v_and_b32_dpp v27, v39, v5 row_ror:10 row_mask:0xf bank_mask:0xf
    v_exp_f32 v28, v28
    v_mfma_f32_16x16x32_bf16 v[48:51], v[104:107], v[20:23], v[48:51]
    v_and_b32_dpp v16, v39, v2 row_ror:6 row_mask:0xf bank_mask:0xf
    v_and_b32_dpp v17, v39, v3 row_ror:10 row_mask:0xf bank_mask:0xf
    v_cvt_pk_bf16_f32 v40, v28, v28
    v_mfma_f32_16x16x32_bf16 v[52:55], v[108:111], v[20:23], v[52:55]
    v_and_b32_dpp v18, v39, v4 row_ror:14 row_mask:0xf bank_mask:0xf
    v_and_b32_dpp v19, v39, v5 row_ror:2 row_mask:0xf bank_mask:0xf
    v_add_f32 v63, v63, v28
    v_mfma_f32_16x16x32_bf16 v[48:51], v[112:115], v[24:27], v[48:51]
    v_and_b32_dpp v20, v40, v2 row_ror:14 row_mask:0xf bank_mask:0xf
    v_and_b32_dpp v21, v40, v3 row_ror:2 row_mask:0xf bank_mask:0xf
    v_sub_f32 v29, v41, v62
    v_lshlrev_b32 v57, 2, v57
    v_mfma_f32_16x16x32_bf16 v[52:55], v[116:119], v[24:27], v[52:55]
    v_and_b32_dpp v22, v40, v4 row_ror:6 row_mask:0xf bank_mask:0xf
    v_and_b32_dpp v23, v40, v5 row_ror:10 row_mask:0xf bank_mask:0xf
    v_exp_f32 v29, v29
    v_mfma_f32_16x16x32_bf16 v[48:51], v[120:123], v[16:19], v[48:51]
    v_and_b32_dpp v24, v40, v2 row_ror:6 row_mask:0xf bank_mask:0xf
    v_and_b32_dpp v25, v40, v3 row_ror:10 row_mask:0xf bank_mask:0xf
    v_cvt_pk_bf16_f32 v41, v29, v29
    v_mfma_f32_16x16x32_bf16 v[52:55], v[124:127], v[16:19], v[52:55]
    v_and_b32_dpp v26, v40, v4 row_ror:14 row_mask:0xf bank_mask:0xf
    v_and_b32_dpp v27, v40, v5 row_ror:2 row_mask:0xf bank_mask:0xf
    v_add_f32 v63, v63, v29
    v_mfma_f32_16x16x32_bf16 v[48:51], v[128:131], v[20:23], v[48:51]
    v_and_b32_dpp v16, v41, v2 row_ror:14 row_mask:0xf bank_mask:0xf
    v_and_b32_dpp v17, v41, v3 row_ror:2 row_mask:0xf bank_mask:0xf
    v_sub_f32 v28, v42, v62
    v_add_u32 v57, 57344, v57
    v_mfma_f32_16x16x32_bf16 v[52:55], v[132:135], v[20:23], v[52:55]
    v_and_b32_dpp v18, v41, v4 row_ror:6 row_mask:0xf bank_mask:0xf
    v_and_b32_dpp v19, v41, v5 row_ror:10 row_mask:0xf bank_mask:0xf
    v_exp_f32 v28, v28
    v_mfma_f32_16x16x32_bf16 v[48:51], v[136:139], v[24:27], v[48:51]
    v_and_b32_dpp v20, v41, v2 row_ror:6 row_mask:0xf bank_mask:0xf
    v_and_b32_dpp v21, v41, v3 row_ror:10 row_mask:0xf bank_mask:0xf
    v_cvt_pk_bf16_f32 v42, v28, v28
    v_mfma_f32_16x16x32_bf16 v[52:55], v[140:143], v[24:27], v[52:55]
    v_and_b32_dpp v22, v41, v4 row_ror:14 row_mask:0xf bank_mask:0xf
    v_and_b32_dpp v23, v41, v5 row_ror:2 row_mask:0xf bank_mask:0xf
    v_add_f32 v63, v63, v28
    v_lshlrev_b32 v31, 7, v0
    s_mov_b64 exec, s[60:61]
    buffer_load_dword v61, v31, s[16:19], s80 offen sc1
    buffer_load_dword v61, off, s[16:19], s81 sc1
    s_mov_b64 exec, -1
    v_mfma_f32_16x16x32_bf16 v[48:51], v[144:147], v[16:19], v[48:51]
    v_and_b32_dpp v24, v42, v2 row_ror:14 row_mask:0xf bank_mask:0xf
    v_and_b32_dpp v25, v42, v3 row_ror:2 row_mask:0xf bank_mask:0xf
    v_sub_f32 v29, v43, v62
    s_lshl_b32 s76, s3, 3
    s_add_u32 s76, s76, 56832
    v_mov_b32 v58, s76
    v_mfma_f32_16x16x32_bf16 v[52:55], v[148:151], v[16:19], v[52:55]
    v_and_b32_dpp v26, v42, v4 row_ror:6 row_mask:0xf bank_mask:0xf
    v_and_b32_dpp v27, v42, v5 row_ror:10 row_mask:0xf bank_mask:0xf
    v_exp_f32 v29, v29
    v_mfma_f32_16x16x32_bf16 v[48:51], v[152:155], v[20:23], v[48:51]
    v_and_b32_dpp v16, v42, v2 row_ror:6 row_mask:0xf bank_mask:0xf
    v_and_b32_dpp v17, v42, v3 row_ror:10 row_mask:0xf bank_mask:0xf
    v_cvt_pk_bf16_f32 v43, v29, v29
    v_mfma_f32_16x16x32_bf16 v[52:55], v[156:159], v[20:23], v[52:55]
    v_and_b32_dpp v18, v42, v4 row_ror:14 row_mask:0xf bank_mask:0xf
    v_and_b32_dpp v19, v42, v5 row_ror:2 row_mask:0xf bank_mask:0xf
    v_add_f32 v63, v63, v29
    v_mfma_f32_16x16x32_bf16 v[48:51], v[160:163], v[24:27], v[48:51]
    v_and_b32_dpp v20, v43, v2 row_ror:14 row_mask:0xf bank_mask:0xf
    v_and_b32_dpp v21, v43, v3 row_ror:2 row_mask:0xf bank_mask:0xf
    v_sub_f32 v28, v44, v62
    v_mfma_f32_16x16x32_bf16 v[52:55], v[164:167], v[24:27], v[52:55]
    v_and_b32_dpp v22, v43, v4 row_ror:6 row_mask:0xf bank_mask:0xf
    v_and_b32_dpp v23, v43, v5 row_ror:10 row_mask:0xf bank_mask:0xf
    v_exp_f32 v28, v28
    v_mfma_f32_16x16x32_bf16 v[48:51], v[168:171], v[16:19], v[48:51]
    v_and_b32_dpp v24, v43, v2 row_ror:6 row_mask:0xf bank_mask:0xf
    v_and_b32_dpp v25, v43, v3 row_ror:10 row_mask:0xf bank_mask:0xf
    v_cvt_pk_bf16_f32 v44, v28, v28
    v_mfma_f32_16x16x32_bf16 v[52:55], v[172:175], v[16:19], v[52:55]
    v_and_b32_dpp v26, v43, v4 row_ror:14 row_mask:0xf bank_mask:0xf
    v_and_b32_dpp v27, v43, v5 row_ror:2 row_mask:0xf bank_mask:0xf
    v_add_f32 v63, v63, v28
    v_mfma_f32_16x16x32_bf16 v[48:51], v[176:179], v[20:23], v[48:51]
    v_and_b32_dpp v16, v44, v2 row_ror:14 row_mask:0xf bank_mask:0xf
    v_and_b32_dpp v17, v44, v3 row_ror:2 row_mask:0xf bank_mask:0xf
    v_sub_f32 v29, v45, v62
    v_mfma_f32_16x16x32_bf16 v[52:55], v[180:183], v[20:23], v[52:55]
    v_and_b32_dpp v18, v44, v4 row_ror:6 row_mask:0xf bank_mask:0xf
    v_and_b32_dpp v19, v44, v5 row_ror:10 row_mask:0xf bank_mask:0xf
    v_exp_f32 v29, v29
    v_mfma_f32_16x16x32_bf16 v[48:51], v[184:187], v[24:27], v[48:51]
    v_and_b32_dpp v20, v44, v2 row_ror:6 row_mask:0xf bank_mask:0xf
    v_and_b32_dpp v21, v44, v3 row_ror:10 row_mask:0xf bank_mask:0xf
    v_cvt_pk_bf16_f32 v45, v29, v29
    v_mfma_f32_16x16x32_bf16 v[52:55], v[188:191], v[24:27], v[52:55]
    v_and_b32_dpp v22, v44, v4 row_ror:14 row_mask:0xf bank_mask:0xf
    v_and_b32_dpp v23, v44, v5 row_ror:2 row_mask:0xf bank_mask:0xf
    v_add_f32 v63, v63, v29
    v_mfma_f32_16x16x32_bf16 v[48:51], v[192:195], v[16:19], v[48:51]
    v_and_b32_dpp v24, v45, v2 row_ror:14 row_mask:0xf bank_mask:0xf
    v_and_b32_dpp v25, v45, v3 row_ror:2 row_mask:0xf bank_mask:0xf
    v_sub_f32 v28, v46, v62
    v_mfma_f32_16x16x32_bf16 v[52:55], v[196:199], v[16:19], v[52:55]
    v_and_b32_dpp v26, v45, v4 row_ror:6 row_mask:0xf bank_mask:0xf
    v_and_b32_dpp v27, v45, v5 row_ror:10 row_mask:0xf bank_mask:0xf
    v_exp_f32 v28, v28
    v_mfma_f32_16x16x32_bf16 v[48:51], v[200:203], v[20:23], v[48:51]
    v_and_b32_dpp v16, v45, v2 row_ror:6 row_mask:0xf bank_mask:0xf
    v_and_b32_dpp v17, v45, v3 row_ror:10 row_mask:0xf bank_mask:0xf
    v_cvt_pk_bf16_f32 v46, v28, v28
    v_mfma_f32_16x16x32_bf16 v[52:55], v[204:207], v[20:23], v[52:55]
    v_and_b32_dpp v18, v45, v4 row_ror:14 row_mask:0xf bank_mask:0xf
    v_and_b32_dpp v19, v45, v5 row_ror:2 row_mask:0xf bank_mask:0xf
    v_add_f32 v63, v63, v28
    v_mfma_f32_16x16x32_bf16 v[48:51], v[208:211], v[24:27], v[48:51]
    v_and_b32_dpp v20, v46, v2 row_ror:14 row_mask:0xf bank_mask:0xf
    v_and_b32_dpp v21, v46, v3 row_ror:2 row_mask:0xf bank_mask:0xf
    v_sub_f32 v29, v47, v62
    v_mfma_f32_16x16x32_bf16 v[52:55], v[212:215], v[24:27], v[52:55]
    v_and_b32_dpp v22, v46, v4 row_ror:6 row_mask:0xf bank_mask:0xf
    v_and_b32_dpp v23, v46, v5 row_ror:10 row_mask:0xf bank_mask:0xf
    v_exp_f32 v29, v29
    v_mfma_f32_16x16x32_bf16 v[48:51], v[216:219], v[16:19], v[48:51]
    v_and_b32_dpp v24, v46, v2 row_ror:6 row_mask:0xf bank_mask:0xf
    v_and_b32_dpp v25, v46, v3 row_ror:10 row_mask:0xf bank_mask:0xf
    v_cvt_pk_bf16_f32 v47, v29, v29
    v_mfma_f32_16x16x32_bf16 v[52:55], v[220:223], v[16:19], v[52:55]
    v_and_b32_dpp v26, v46, v4 row_ror:14 row_mask:0xf bank_mask:0xf
    v_and_b32_dpp v27, v46, v5 row_ror:2 row_mask:0xf bank_mask:0xf
    v_add_f32 v63, v63, v29
    v_mfma_f32_16x16x32_bf16 v[48:51], v[224:227], v[20:23], v[48:51]
    v_and_b32_dpp v16, v47, v2 row_ror:14 row_mask:0xf bank_mask:0xf
    v_and_b32_dpp v17, v47, v3 row_ror:2 row_mask:0xf bank_mask:0xf
    v_add_f32_dpp v63, v63, v63 row_ror:4 row_mask:0xf bank_mask:0xf
    v_mfma_f32_16x16x32_bf16 v[52:55], v[228:231], v[20:23], v[52:55]
    v_and_b32_dpp v18, v47, v4 row_ror:6 row_mask:0xf bank_mask:0xf
    v_and_b32_dpp v19, v47, v5 row_ror:10 row_mask:0xf bank_mask:0xf
    v_mfma_f32_16x16x32_bf16 v[48:51], v[232:235], v[24:27], v[48:51]
    v_and_b32_dpp v20, v47, v2 row_ror:6 row_mask:0xf bank_mask:0xf
    v_and_b32_dpp v21, v47, v3 row_ror:10 row_mask:0xf bank_mask:0xf
    v_add_f32_dpp v63, v63, v63 row_ror:8 row_mask:0xf bank_mask:0xf
    v_mfma_f32_16x16x32_bf16 v[52:55], v[236:239], v[24:27], v[52:55]
    v_and_b32_dpp v22, v47, v4 row_ror:14 row_mask:0xf bank_mask:0xf
    v_and_b32_dpp v23, v47, v5 row_ror:2 row_mask:0xf bank_mask:0xf
    v_mfma_f32_16x16x32_bf16 v[48:51], v[240:243], v[16:19], v[48:51]
    v_add_f32_dpp v63, v63, v63 row_bcast:15 row_mask:0xa bank_mask:0xf
    v_mfma_f32_16x16x32_bf16 v[52:55], v[244:247], v[16:19], v[52:55]
    v_mfma_f32_16x16x32_bf16 v[48:51], v[248:251], v[20:23], v[48:51]
    v_add_f32_dpp v63, v63, v63 row_bcast:31 row_mask:0xc bank_mask:0xf
    v_mfma_f32_16x16x32_bf16 v[52:55], v[252:255], v[20:23], v[52:55]
    s_cmp_lg_u32 s46, 0
    s_cbranch_scc1 L_dry_back
    s_branch L_chain
L_fin:
    s_lshl_b32 s75, s5, 5
    buffer_store_dword v13, v83, s[48:51], s75 offen
L_done:
L_end:
    s_endpgm
L_S2w:
    s_sleep 4
    s_branch L_S2
L_slow_14:
    buffer_store_dword v90, v27, s[16:19], s78 offen sc1
    s_mov_b64 exec, 1
    buffer_store_dwordx2 v[88:89], v29, s[16:19], s79 offen sc1
    s_mov_b64 exec, -1
    s_branch L_back_15
L_exact_20:
    v_max_u32 v89, v64, v65
    v_max3_u32 v89, v89, v66, v67
    v_max3_u32 v89, v89, v68, v69
    v_max3_u32 v89, v89, v70, v71
    v_max3_u32 v89, v89, v72, v73
    v_max3_u32 v89, v89, v74, v75
    v_max3_u32 v89, v89, v76, v77
    v_max3_u32 v89, v89, v78, v79
    v_cmp_eq_u32 vcc, -1, v89
    s_cmp_lt_u32 s68, 100000
    s_cselect_b64 s[64:65], -1, 0
    s_and_b64 vcc, vcc, s[64:65]
    s_cbranch_scc1 L_poll_18
    s_waitcnt vmcnt(0)
    v_pk_add_f32 v[90:91], v[64:65], v[66:67]
    v_pk_add_f32 v[92:93], v[68:69], v[70:71]
    v_pk_add_f32 v[94:95], v[72:73], v[74:75]
    v_pk_add_f32 v[96:97], v[76:77], v[78:79]
    v_pk_add_f32 v[90:91], v[90:91], v[92:93]
    v_pk_add_f32 v[94:95], v[94:95], v[96:97]
    v_pk_add_f32 v[90:91], v[90:91], v[80:81]
    v_pk_add_f32 v[90:91], v[90:91], v[94:95]
    s_cmp_eq_u32 s69, 0
    s_branch L_ok_19
L_slow_21:
    buffer_store_dword v90, v83, s[16:19], s84 offen sc1
    s_branch L_back_22
L_slow_24:
    buffer_store_dword v64, v98, s[16:19], s86 offen sc1
    s_branch L_back_25
L_exact_29:
    v_max_u32 v89, v64, v65
    v_max3_u32 v89, v89, v66, v67
    v_max3_u32 v89, v89, v68, v69
    v_max3_u32 v89, v89, v70, v71
    v_max3_u32 v89, v89, v72, v73
    v_max3_u32 v89, v89, v74, v75
    v_max3_u32 v89, v89, v76, v77
    v_max3_u32 v89, v89, v78, v79
    v_cmp_eq_u32 vcc, -1, v89
    s_cmp_lt_u32 s68, 100000
    s_cselect_b64 s[64:65], -1, 0
    s_and_b64 vcc, vcc, s[64:65]
    s_cbranch_scc1 L_poll_27
    s_waitcnt vmcnt(0)
    v_pk_add_f32 v[90:91], v[64:65], v[66:67]
    v_pk_add_f32 v[92:93], v[68:69], v[70:71]
    v_pk_add_f32 v[94:95], v[72:73], v[74:75]
    v_pk_add_f32 v[96:97], v[76:77], v[78:79]
    v_pk_add_f32 v[90:91], v[90:91], v[92:93]
    v_pk_add_f32 v[94:95], v[94:95], v[96:97]
    v_pk_add_f32 v[90:91], v[90:91], v[80:81]
    v_pk_add_f32 v[90:91], v[90:91], v[94:95]
    s_cmp_eq_u32 s69, 0
    s_branch L_ok_28
L_slow_30:
    buffer_store_dword v90, v83, s[16:19], s90 offen sc1
    s_branch L_back_31
L_slow_33:
    buffer_store_dword v64, v98, s[16:19], s92 offen sc1
    s_branch L_back_34
L_code_end:
.section .rodata,"a"
.p2align 6
.amdhsa_kernel interleave_layers__gqa_block_cached__dense_activation_gelu__decode_kernel
  .amdhsa_next_free_vgpr 512
  .amdhsa_next_free_sgpr 102
  .amdhsa_accum_offset 256
  .amdhsa_group_segment_fixed_size 0
  .amdhsa_kernarg_size 104
  .amdhsa_user_sgpr_count 2
  .amdhsa_user_sgpr_kernarg_segment_ptr 1
  .amdhsa_system_sgpr_workgroup_id_x 1
  .amdhsa_float_denorm_mode_32 3
.end_amdhsa_kernel
```
